```python
import torch

def _softmax(x, axis=-1):
    return torch.softmax(x, dim=axis)
def _gelu(x):
    return torch.nn.functional.gelu(x, approximate="tanh")
def _silu(x):
    return torch.nn.functional.silu(x)
def _sigmoid(x):
    return torch.sigmoid(x)
def _layernorm(x, axis=-1, eps=1e-5):
    m = x.mean(dim=axis, keepdim=True)
    v = x.var(dim=axis, keepdim=True, unbiased=False)
    return (x - m) / torch.sqrt(v + eps)
def _scatter_add(tgt, idx, src, axis=0):
    return tgt.clone().index_add_(axis, idx, src)
def _segment_sum(src, seg, n):
    out = torch.zeros((n,) + src.shape[1:], dtype=src.dtype)
    return out.index_add_(0, seg, src)
def _pad(x, pw):
    flat = tuple(v for pair in reversed(pw) for v in pair)
    return torch.nn.functional.pad(x, flat)

kernel_name = 'sequential_preLN__gqa_block_cached__geglu_ffn__decode'

def setup_inputs():

    _w = (lambda a: (lambda t: t.to(torch.bfloat16) if t.is_floating_point() else t)(torch.as_tensor(a)))
    def _A_setup():
        B, Sq, D = 2, 1, 448
        Hq, Hkv, Sk, Dh = 16, 8, 32768, 256
        assert Hq % Hkv == 0, (Hq, Hkv)
        return {
            "x": _w((lambda *s: torch.randn(*s, dtype=torch.bfloat16) * 0.05)(B, Sq, D)),
            "k_cache": _w((lambda *s: torch.randn(*s, dtype=torch.bfloat16) * 3.2)(B, Hkv, Sk, Dh)),
            "v_cache": _w((lambda *s: torch.randn(*s, dtype=torch.bfloat16) * 0.4)(B, Hkv, Sk, Dh)),
            "wq": _w((lambda *s: torch.randn(*s, dtype=torch.bfloat16) * 3.2)(D, Hq * Dh) * (D ** -0.5)),
            "wo": _w((lambda *s: torch.randn(*s, dtype=torch.bfloat16) * 0.4)(Hq * Dh, D) * ((Hq * Dh) ** -0.5)),
        }
    _A_in = _A_setup()

    def _B_setup():
        B, S, D, F = 2, 1, 448, 1792
        return {
            "x": _w((lambda *s: torch.randn(*s, dtype=torch.bfloat16) * 0.05)(B, S, D)),
            "w_gate": _w((lambda *s: torch.randn(*s, dtype=torch.bfloat16) * 0.05)(D, F)),
            "w_up": _w((lambda *s: torch.randn(*s, dtype=torch.bfloat16) * 0.05)(D, F)),
            "w_down": _w((lambda *s: torch.randn(*s, dtype=torch.bfloat16) * 0.05)(F, D)),
        }
    _B_in = _B_setup()

    return {
        "A_x": _A_in["x"],
        "A_k_cache": _A_in["k_cache"],
        "A_v_cache": _A_in["v_cache"],
        "A_wq": _A_in["wq"],
        "A_wo": _A_in["wo"],
        "B_x": _B_in["x"],
        "B_w_gate": _B_in["w_gate"],
        "B_w_up": _B_in["w_up"],
        "B_w_down": _B_in["w_down"],
    }

def reference(A_x, A_k_cache, A_v_cache, A_wq, A_wo, B_x, B_w_gate, B_w_up, B_w_down):
    def _A_ref(x, k_cache, v_cache, wq, wo):
        B, Sq, D = x.shape
        Hq, Dh = 16, 256
        Hkv = k_cache.shape[1]
        rep = Hq // Hkv
        q = (lambda x, *d: x.permute(*d))((x @ wq).reshape(B, Sq, Hq, Dh), 0, 2, 1, 3)
        k = (lambda x, n, axis: torch.repeat_interleave(x, n, dim=axis))(k_cache, rep, axis=1)
        v = (lambda x, n, axis: torch.repeat_interleave(x, n, dim=axis))(v_cache, rep, axis=1)
        scores = torch.einsum("bhqd,bhkd->bhqk", q, k) * (Dh ** -0.5)
        p = _softmax(scores, axis=-1)
        o = torch.einsum("bhqk,bhkd->bhqd", p, v)
        return (lambda x, *d: x.permute(*d))(o, 0, 2, 1, 3).reshape(B, Sq, Hq * Dh) @ wo

    def _B_ref(x, w_gate, w_up, w_down):
        return (_gelu(x @ w_gate) * (x @ w_up)) @ w_down

    x = A_x
    h = x + _A_ref(_layernorm(x, axis=-1), A_k_cache, A_v_cache, A_wq, A_wo)
    h2 = h + _B_ref(_layernorm(h, axis=-1), B_w_gate, B_w_up, B_w_down)
    return h2
```

```asm
; @launch grid=(256,1,1) block=(512,1,1) lds=133184
.amdgcn_target "amdgcn-amd-amdhsa--gfx950"
.text
.globl sequential_preLN__gqa_block_cached__geglu_ffn__decode_kernel
.p2align 8
.type sequential_preLN__gqa_block_cached__geglu_ffn__decode_kernel,@function
sequential_preLN__gqa_block_cached__geglu_ffn__decode_kernel:
  s_cmp_ge_u32 s2, 256
  s_cbranch_scc1 L_end
  s_load_dwordx16 s[16:31], s[0:1], 0
  s_load_dwordx8 s[32:39], s[0:1], 64
  v_lshrrev_b32 v26, 6, v0
  v_and_b32 v1, 63, v0
  v_readfirstlane_b32 s56, v26
  s_lshr_b32 s57, s2, 4
  s_and_b32 s58, s2, 15
  s_lshr_b32 s59, s2, 7
  s_and_b32 s60, s57, 7
  v_lshrrev_b32 v26, 4, v1
  v_bfe_u32 v27, v1, 2, 2
  v_lshlrev_b32 v27, 9, v27
  v_and_b32 v28, 3, v1
  v_lshlrev_b32 v28, 4, v28
  v_lshl_add_u32 v2, v26, 6, v27
  s_lshl_b32 s77, s56, 12
  v_add3_u32 v2, v2, v28, s77
  v_and_b32 v27, 15, v1
  v_lshlrev_b32 v27, 4, v27
  v_lshl_add_u32 v3, v26, 9, v27
  v_add_u32 v3, s77, v3
  s_mul_i32 s65, s58, 688128
  s_mul_i32 s77, s56, 20480
  s_add_u32 s65, s65, s77
  s_mov_b32 s8, s65
  s_mov_b32 s100, 0
  s_mov_b32 s9, 0
  s_mov_b32 s10, 0
  s_mov_b32 s11, 0
  s_mov_b32 s70, 0x3db8aa3b
  s_mov_b32 s67, 133120
  s_mov_b32 s76, 0
  s_mov_b32 s71, 0
  s_mov_b32 s101, 0
  v_bfe_u32 v29, v1, 3, 1
  v_mul_u32_u24 v29, 896, v29
  v_and_b32 v28, 7, v1
  v_lshl_add_u32 v28, v26, 3, v28
  v_mul_u32_u24 v28, 28, v28
  v_add_u32 v48, v28, v29
  v_mul_u32_u24 v49, 28, v26
  v_add_u32 v49, v49, v29
  v_mul_u32_u24 v50, 114688, v26
  v_add_u32 v50, v50, v27
  s_and_b32 s77, s2, 7
  s_mul_i32 s3, s77, 112
  s_mul_i32 s4, s77, 458752
  s_lshr_b32 s79, s2, 3
  s_lshl_b32 s79, s79, 8
  s_add_u32 s4, s4, s79
  s_mov_b32 s42, 0x1000000
  s_mov_b32 s43, 0x20000
  s_mov_b32 s46, 0x1000000
  s_mov_b32 s47, 0x20000
  s_mov_b32 s54, 2801664
  s_mov_b32 s55, 0x20000
  s_mov_b32 s50, 3670016
  s_mov_b32 s51, 0x20000
  s_mov_b32 s14, 1792
  s_mov_b32 s15, 0x20000
  s_lshl_b32 s78, s57, 24
  s_mul_i32 s79, s57, 4352
  s_add_u32 s79, s79, 4096
  s_cmp_eq_u32 s56, 0
  s_waitcnt lgkmcnt(0)
  s_cbranch_scc1 L_w0
  s_add_u32 s40, s18, s78
  s_addc_u32 s41, s19, 0
  s_add_u32 s44, s20, s78
  s_addc_u32 s45, s21, 0
  s_mov_b32 s52, s38
  s_mov_b32 s53, s39
  s_add_u32 s72, s38, s79
  s_addc_u32 s73, s39, 0
  s_cmp_eq_u32 s56, 7
  s_cbranch_scc1 L_w7
  s_barrier
L_pf:
  buffer_load_dwordx4 v[64:67], v2, s[40:43], s65 offen offset:0 nt
  buffer_load_dwordx4 v[68:71], v2, s[40:43], s65 offen offset:256 nt
  buffer_load_dwordx4 v[72:75], v2, s[40:43], s8 offen offset:2048 nt
  buffer_load_dwordx4 v[76:79], v2, s[40:43], s8 offen offset:2304 nt
  buffer_load_dwordx4 v[80:83], v3, s[44:47], s65 offen offset:0 nt
  buffer_load_dwordx4 v[84:87], v3, s[44:47], s65 offen offset:256 nt
  buffer_load_dwordx4 v[88:91], v3, s[44:47], s8 offen offset:2048 nt
  buffer_load_dwordx4 v[92:95], v3, s[44:47], s8 offen offset:2304 nt
  s_add_u32 s65, s65, 4096
  s_mov_b32 s8, s65
  v_and_b32 v26, 1, v1
  v_lshlrev_b32 v26, 4, v26
  v_mov_b32 v27, 0xffff
  v_lshlrev_b32 v26, v26, v27
  v_bfe_u32 v27, v1, 1, 2
  v_cmp_eq_u32 vcc, 0, v27
  s_nop 1
  v_cndmask_b32 v12, 0, v26, vcc
  v_cmp_eq_u32 vcc, 1, v27
  s_nop 1
  v_cndmask_b32 v13, 0, v26, vcc
  v_cmp_eq_u32 vcc, 2, v27
  s_nop 1
  v_cndmask_b32 v14, 0, v26, vcc
  v_cmp_eq_u32 vcc, 3, v27
  s_nop 1
  v_cndmask_b32 v15, 0, v26, vcc
  v_mov_b32 v16, 0
  v_mov_b32 v17, 0
  v_mov_b32 v18, 0
  v_mov_b32 v19, 0
  v_mov_b32 v20, 0
  v_mov_b32 v21, 0
  v_mov_b32 v22, 0
  v_mov_b32 v23, 0
  v_mov_b32 v24, 0xff7fffff
  v_mov_b32 v25, 0
  v_mov_b32 v55, 0
  v_mov_b32 v58, 0
  v_mov_b32 v61, 0
  v_mov_b32 v62, 0
  v_mov_b32 v63, 0
  s_mov_b32 s68, 0
  s_mov_b32 s69, s57
  s_lshr_b32 s97, s58, 3
  s_mov_b32 s99, 108
  s_and_b32 s77, s58, 7
  s_cbranch_scc1 L_role_2
  s_cmp_ge_u32 s57, 14
  s_cbranch_scc1 L_role_1
  s_mov_b32 s68, 2
  s_lshl_b32 s69, s57, 1
  s_add_u32 s69, s69, s97
  s_mov_b32 s99, 108
  s_branch L_role_1
L_role_2:
  s_xor_b32 s79, s57, 0
  s_mul_i32 s78, s79, 37
  s_lshr_b32 s78, s78, 8
  s_mul_i32 s78, s78, 7
  s_sub_u32 s78, s79, s78
  s_add_u32 s78, s78, 1
  s_cmp_lg_u32 s78, s77
  s_cbranch_scc1 L_role_3
  s_mov_b32 s68, 1
  s_mov_b32 s69, s79
  s_add_u32 s97, s97, 0
  s_mov_b32 s99, 108
  s_branch L_role_1
L_role_3:
  s_xor_b32 s79, s57, 8
  s_mul_i32 s78, s79, 37
  s_lshr_b32 s78, s78, 8
  s_mul_i32 s78, s78, 7
  s_sub_u32 s78, s79, s78
  s_add_u32 s78, s78, 1
  s_cmp_lg_u32 s78, s77
  s_cbranch_scc1 L_role_4
  s_mov_b32 s68, 1
  s_mov_b32 s69, s79
  s_add_u32 s97, s97, 2
  s_mov_b32 s99, 108
  s_branch L_role_1
L_role_4:
L_role_1:
  s_waitcnt vmcnt(40)
  buffer_load_dwordx4 v[96:99], v2, s[40:43], s65 offen offset:0 nt
  buffer_load_dwordx4 v[100:103], v2, s[40:43], s65 offen offset:256 nt
  buffer_load_dwordx4 v[104:107], v2, s[40:43], s8 offen offset:2048 nt
  buffer_load_dwordx4 v[108:111], v2, s[40:43], s8 offen offset:2304 nt
  buffer_load_dwordx4 v[112:115], v3, s[44:47], s65 offen offset:0 nt
  buffer_load_dwordx4 v[116:119], v3, s[44:47], s65 offen offset:256 nt
  buffer_load_dwordx4 v[120:123], v3, s[44:47], s8 offen offset:2048 nt
  buffer_load_dwordx4 v[124:127], v3, s[44:47], s8 offen offset:2304 nt
  s_add_u32 s65, s65, 4096
  s_mov_b32 s8, s65
  s_waitcnt vmcnt(40)
  buffer_load_dwordx4 v[128:131], v2, s[40:43], s65 offen offset:0 nt
  buffer_load_dwordx4 v[132:135], v2, s[40:43], s65 offen offset:256 nt
  buffer_load_dwordx4 v[136:139], v2, s[40:43], s8 offen offset:2048 nt
  buffer_load_dwordx4 v[140:143], v2, s[40:43], s8 offen offset:2304 nt
  buffer_load_dwordx4 v[144:147], v3, s[44:47], s65 offen offset:0 nt
  buffer_load_dwordx4 v[148:151], v3, s[44:47], s65 offen offset:256 nt
  buffer_load_dwordx4 v[152:155], v3, s[44:47], s8 offen offset:2048 nt
  buffer_load_dwordx4 v[156:159], v3, s[44:47], s8 offen offset:2304 nt
  s_add_u32 s65, s65, 4096
  s_mov_b32 s8, s65
  s_waitcnt vmcnt(40)
  buffer_load_dwordx4 v[160:163], v2, s[40:43], s65 offen offset:0 nt
  buffer_load_dwordx4 v[164:167], v2, s[40:43], s65 offen offset:256 nt
  buffer_load_dwordx4 v[168:171], v2, s[40:43], s8 offen offset:2048 nt
  buffer_load_dwordx4 v[172:175], v2, s[40:43], s8 offen offset:2304 nt
  buffer_load_dwordx4 v[176:179], v3, s[44:47], s65 offen offset:0 nt
  buffer_load_dwordx4 v[180:183], v3, s[44:47], s65 offen offset:256 nt
  buffer_load_dwordx4 v[184:187], v3, s[44:47], s8 offen offset:2048 nt
  buffer_load_dwordx4 v[188:191], v3, s[44:47], s8 offen offset:2304 nt
  s_add_u32 s65, s65, 4096
  s_mov_b32 s8, s65
  s_waitcnt vmcnt(40)
  buffer_load_dwordx4 v[192:195], v2, s[40:43], s65 offen offset:0 nt
  buffer_load_dwordx4 v[196:199], v2, s[40:43], s65 offen offset:256 nt
  buffer_load_dwordx4 v[200:203], v2, s[40:43], s8 offen offset:2048 nt
  buffer_load_dwordx4 v[204:207], v2, s[40:43], s8 offen offset:2304 nt
  buffer_load_dwordx4 v[208:211], v3, s[44:47], s65 offen offset:0 nt
  buffer_load_dwordx4 v[212:215], v3, s[44:47], s65 offen offset:256 nt
  buffer_load_dwordx4 v[216:219], v3, s[44:47], s8 offen offset:2048 nt
  buffer_load_dwordx4 v[220:223], v3, s[44:47], s8 offen offset:2304 nt
  s_add_u32 s65, s65, 4096
  s_mov_b32 s8, s65
  s_waitcnt vmcnt(40)
  buffer_load_dwordx4 v[224:227], v2, s[40:43], s65 offen offset:0 nt
  buffer_load_dwordx4 v[228:231], v2, s[40:43], s65 offen offset:256 nt
  buffer_load_dwordx4 v[232:235], v2, s[40:43], s8 offen offset:2048 nt
  buffer_load_dwordx4 v[236:239], v2, s[40:43], s8 offen offset:2304 nt
  buffer_load_dwordx4 v[240:243], v3, s[44:47], s65 offen offset:0 nt
  buffer_load_dwordx4 v[244:247], v3, s[44:47], s65 offen offset:256 nt
  buffer_load_dwordx4 v[248:251], v3, s[44:47], s8 offen offset:2048 nt
  buffer_load_dwordx4 v[252:255], v3, s[44:47], s8 offen offset:2304 nt
  s_mul_i32 s65, s58, 688128
  s_add_u32 s65, s65, 196608
  s_mov_b32 s8, s65
  s_barrier
  s_branch L_qrdy
L_w7:
  s_load_dword s61, s[38:39], 0
  s_mov_b32 s62, 1572864
  s_load_dword s62, s[38:39], s62
  s_barrier
  s_mov_b32 s68, 0
  s_mov_b32 s69, s57
  s_lshr_b32 s97, s58, 3
  s_mov_b32 s99, 108
  s_and_b32 s77, s58, 7
  s_cbranch_scc1 L_role_6
  s_cmp_ge_u32 s57, 14
  s_cbranch_scc1 L_role_5
  s_mov_b32 s68, 2
  s_lshl_b32 s69, s57, 1
  s_add_u32 s69, s69, s97
  s_mov_b32 s99, 108
  s_branch L_role_5
L_role_6:
  s_xor_b32 s79, s57, 0
  s_mul_i32 s78, s79, 37
  s_lshr_b32 s78, s78, 8
  s_mul_i32 s78, s78, 7
  s_sub_u32 s78, s79, s78
  s_add_u32 s78, s78, 1
  s_cmp_lg_u32 s78, s77
  s_cbranch_scc1 L_role_7
  s_mov_b32 s68, 1
  s_mov_b32 s69, s79
  s_add_u32 s97, s97, 0
  s_mov_b32 s99, 108
  s_branch L_role_5
L_role_7:
  s_xor_b32 s79, s57, 8
  s_mul_i32 s78, s79, 37
  s_lshr_b32 s78, s78, 8
  s_mul_i32 s78, s78, 7
  s_sub_u32 s78, s79, s78
  s_add_u32 s78, s78, 1
  s_cmp_lg_u32 s78, s77
  s_cbranch_scc1 L_role_8
  s_mov_b32 s68, 1
  s_mov_b32 s69, s79
  s_add_u32 s97, s97, 2
  s_mov_b32 s99, 108
  s_branch L_role_5
L_role_8:
L_role_5:
  s_waitcnt lgkmcnt(0)
  s_mul_i32 s61, s61, 0x9e3779b1
  s_mul_i32 s62, s62, 0x85ebca6c
  s_add_u32 s61, s61, s62
  s_add_u32 s61, s61, 0x7f4a7c15
  s_and_b32 s62, s61, 0xfffffc00
  v_mov_b32 v48, -1
  v_mov_b32 v49, -1
  v_mov_b32 v50, -1
  v_mov_b32 v51, -1
  v_lshlrev_b32 v26, 4, v1
  s_lshl_b32 s77, s57, 5
  s_add_u32 s77, s77, s58
  s_lshl_b32 s78, s77, 10
  s_add_u32 s78, s78, 2097152
  buffer_store_dwordx4 v[48:51], v26, s[52:55], s78 offen sc1
  s_add_u32 s78, s78, 16384
  buffer_store_dwordx4 v[48:51], v26, s[52:55], s78 offen sc1
  s_cmp_eq_u32 s68, 0
  s_cbranch_scc1 L_clr1
  s_lshl_b32 s79, s69, 12
  s_cmp_eq_u32 s68, 2
  s_cbranch_scc1 L_clrf
  s_lshl_b32 s78, s97, 10
  s_add_u32 s78, s78, s79
  s_add_u32 s78, s78, 2621440
  buffer_store_dwordx4 v[48:51], v26, s[52:55], s78 offen sc1
  s_branch L_clr1
L_clrf:
  s_add_u32 s78, s79, 2686976
  buffer_store_dwordx4 v[48:51], v26, s[52:55], s78 offen offset:0 sc1
  buffer_store_dwordx4 v[48:51], v26, s[52:55], s78 offen offset:1024 sc1
  buffer_store_dwordx4 v[48:51], v26, s[52:55], s78 offen offset:2048 sc1
  buffer_store_dwordx4 v[48:51], v26, s[52:55], s78 offen offset:3072 sc1
L_clr1:
  s_cmp_lg_u32 s58, 0
  s_cbranch_scc1 L_clr2
  v_mov_b32 v27, 0
  v_mov_b32 v28, s62
  s_mov_b64 exec, 1
  global_store_dword v27, v28, s[72:73] sc1
  s_mov_b64 exec, -1
L_clr2:
  s_waitcnt vmcnt(0)
  s_mov_b32 s96, 1
  s_atomic_add s96, s[36:37], 0
  s_branch L_pf
L_w0:
  s_mov_b32 s12, s16
  s_mov_b32 s13, s17
  s_mov_b32 s48, s22
  s_mov_b32 s49, s23
  buffer_load_dwordx4 v[128:131], v48, s[12:15], 0 offen
  buffer_load_dwordx3 v[132:134], v48, s[12:15], 0 offen offset:16
  buffer_load_dwordx4 v[136:139], v49, s[12:15], s3 offen
  buffer_load_dwordx3 v[140:142], v49, s[12:15], s3 offen offset:16
  buffer_load_dwordx4 v[144:147], v50, s[48:51], s4 offen nt
  s_add_u32 s4, s4, 8192
  buffer_load_dwordx4 v[148:151], v50, s[48:51], s4 offen nt
  s_add_u32 s4, s4, 8192
  buffer_load_dwordx4 v[152:155], v50, s[48:51], s4 offen nt
  s_add_u32 s4, s4, 8192
  buffer_load_dwordx4 v[156:159], v50, s[48:51], s4 offen nt
  s_add_u32 s4, s4, 8192
  buffer_load_dwordx4 v[160:163], v50, s[48:51], s4 offen nt
  s_add_u32 s4, s4, 8192
  buffer_load_dwordx4 v[164:167], v50, s[48:51], s4 offen nt
  s_add_u32 s4, s4, 8192
  buffer_load_dwordx4 v[168:171], v50, s[48:51], s4 offen nt
  s_add_u32 s4, s4, 8192
  buffer_load_dwordx4 v[172:175], v50, s[48:51], s4 offen nt
  s_add_u32 s4, s4, 8192
  buffer_load_dwordx4 v[176:179], v50, s[48:51], s4 offen nt
  s_add_u32 s4, s4, 8192
  buffer_load_dwordx4 v[180:183], v50, s[48:51], s4 offen nt
  s_add_u32 s4, s4, 8192
  buffer_load_dwordx4 v[184:187], v50, s[48:51], s4 offen nt
  s_add_u32 s4, s4, 8192
  buffer_load_dwordx4 v[188:191], v50, s[48:51], s4 offen nt
  s_add_u32 s4, s4, 8192
  buffer_load_dwordx4 v[192:195], v50, s[48:51], s4 offen nt
  s_add_u32 s4, s4, 8192
  buffer_load_dwordx4 v[196:199], v50, s[48:51], s4 offen nt
  s_barrier
  s_setprio 3
  s_load_dword s61, s[38:39], 0
  s_mov_b32 s62, 1572864
  s_load_dword s62, s[38:39], s62
  s_add_u32 s40, s18, s78
  s_addc_u32 s41, s19, 0
  s_add_u32 s44, s20, s78
  s_addc_u32 s45, s21, 0
  s_mov_b32 s52, s38
  s_mov_b32 s53, s39
  s_add_u32 s72, s38, s79
  s_addc_u32 s73, s39, 0
  v_and_b32 v26, 1, v1
  v_lshlrev_b32 v26, 4, v26
  v_mov_b32 v27, 0xffff
  v_lshlrev_b32 v26, v26, v27
  v_bfe_u32 v27, v1, 1, 2
  v_cmp_eq_u32 vcc, 0, v27
  s_nop 1
  v_cndmask_b32 v12, 0, v26, vcc
  v_cmp_eq_u32 vcc, 1, v27
  s_nop 1
  v_cndmask_b32 v13, 0, v26, vcc
  v_cmp_eq_u32 vcc, 2, v27
  s_nop 1
  v_cndmask_b32 v14, 0, v26, vcc
  v_cmp_eq_u32 vcc, 3, v27
  s_nop 1
  v_cndmask_b32 v15, 0, v26, vcc
  v_mov_b32 v16, 0
  v_mov_b32 v17, 0
  v_mov_b32 v18, 0
  v_mov_b32 v19, 0
  v_mov_b32 v20, 0
  v_mov_b32 v21, 0
  v_mov_b32 v22, 0
  v_mov_b32 v23, 0
  v_mov_b32 v24, 0xff7fffff
  v_mov_b32 v25, 0
  v_mov_b32 v55, 0
  v_mov_b32 v58, 0
  v_mov_b32 v61, 0
  v_mov_b32 v62, 0
  v_mov_b32 v63, 0
  s_mov_b32 s68, 0
  s_mov_b32 s69, s57
  s_lshr_b32 s97, s58, 3
  s_mov_b32 s99, 108
  s_and_b32 s77, s58, 7
  s_cbranch_scc1 L_role_10
  s_cmp_ge_u32 s57, 14
  s_cbranch_scc1 L_role_9
  s_mov_b32 s68, 2
  s_lshl_b32 s69, s57, 1
  s_add_u32 s69, s69, s97
  s_mov_b32 s99, 108
  s_branch L_role_9
L_role_10:
  s_xor_b32 s79, s57, 0
  s_mul_i32 s78, s79, 37
  s_lshr_b32 s78, s78, 8
  s_mul_i32 s78, s78, 7
  s_sub_u32 s78, s79, s78
  s_add_u32 s78, s78, 1
  s_cmp_lg_u32 s78, s77
  s_cbranch_scc1 L_role_11
  s_mov_b32 s68, 1
  s_mov_b32 s69, s79
  s_add_u32 s97, s97, 0
  s_mov_b32 s99, 108
  s_branch L_role_9
L_role_11:
  s_xor_b32 s79, s57, 8
  s_mul_i32 s78, s79, 37
  s_lshr_b32 s78, s78, 8
  s_mul_i32 s78, s78, 7
  s_sub_u32 s78, s79, s78
  s_add_u32 s78, s78, 1
  s_cmp_lg_u32 s78, s77
  s_cbranch_scc1 L_role_12
  s_mov_b32 s68, 1
  s_mov_b32 s69, s79
  s_add_u32 s97, s97, 2
  s_mov_b32 s99, 108
  s_branch L_role_9
L_role_12:
L_role_9:
  s_waitcnt lgkmcnt(0)
  s_mul_i32 s61, s61, 0x9e3779b1
  s_mul_i32 s62, s62, 0x85ebca6c
  s_add_u32 s61, s61, s62
  s_add_u32 s61, s61, 0x7f4a7c15
  s_and_b32 s62, s61, 0xfffffc00
  s_waitcnt vmcnt(14)
  v_lshlrev_b32 v200, 16, v128
  v_and_b32 v201, 0xffff0000, v128
  v_lshlrev_b32 v202, 16, v129
  v_and_b32 v203, 0xffff0000, v129
  v_lshlrev_b32 v204, 16, v130
  v_and_b32 v205, 0xffff0000, v130
  v_lshlrev_b32 v206, 16, v131
  v_and_b32 v207, 0xffff0000, v131
  v_lshlrev_b32 v208, 16, v132
  v_and_b32 v209, 0xffff0000, v132
  v_lshlrev_b32 v210, 16, v133
  v_and_b32 v211, 0xffff0000, v133
  v_lshlrev_b32 v212, 16, v134
  v_and_b32 v213, 0xffff0000, v134
  v_add_f32 v26, v200, v201
  v_add_f32 v27, v202, v203
  v_add_f32 v26, v26, v204
  v_add_f32 v27, v27, v205
  v_add_f32 v26, v26, v206
  v_add_f32 v27, v27, v207
  v_add_f32 v26, v26, v208
  v_add_f32 v27, v27, v209
  v_add_f32 v26, v26, v210
  v_add_f32 v27, v27, v211
  v_add_f32 v26, v26, v212
  v_add_f32 v27, v27, v213
  v_add_f32 v26, v26, v27
  s_nop 1
  v_add_f32_dpp v26, v26, v26 quad_perm:[1,0,3,2] row_mask:0xf bank_mask:0xf
  s_nop 1
  v_add_f32_dpp v26, v26, v26 quad_perm:[2,3,0,1] row_mask:0xf bank_mask:0xf
  s_nop 1
  v_add_f32_dpp v26, v26, v26 row_half_mirror row_mask:0xf bank_mask:0xf
  v_mov_b32 v27, v26
  s_nop 1
  v_permlane16_swap_b32 v26, v27
  v_add_f32 v26, v26, v27
  v_mov_b32 v27, v26
  s_nop 1
  v_permlane32_swap_b32 v26, v27
  v_add_f32 v26, v26, v27
  v_mul_f32 v28, 0x3b124925, v26
  v_sub_f32 v200, v200, v28
  v_sub_f32 v201, v201, v28
  v_sub_f32 v202, v202, v28
  v_sub_f32 v203, v203, v28
  v_sub_f32 v204, v204, v28
  v_sub_f32 v205, v205, v28
  v_sub_f32 v206, v206, v28
  v_sub_f32 v207, v207, v28
  v_sub_f32 v208, v208, v28
  v_sub_f32 v209, v209, v28
  v_sub_f32 v210, v210, v28
  v_sub_f32 v211, v211, v28
  v_sub_f32 v212, v212, v28
  v_sub_f32 v213, v213, v28
  v_mul_f32 v26, v200, v200
  v_mul_f32 v27, v201, v201
  v_fmac_f32 v26, v202, v202
  v_fmac_f32 v27, v203, v203
  v_fmac_f32 v26, v204, v204
  v_fmac_f32 v27, v205, v205
  v_fmac_f32 v26, v206, v206
  v_fmac_f32 v27, v207, v207
  v_fmac_f32 v26, v208, v208
  v_fmac_f32 v27, v209, v209
  v_fmac_f32 v26, v210, v210
  v_fmac_f32 v27, v211, v211
  v_fmac_f32 v26, v212, v212
  v_fmac_f32 v27, v213, v213
  v_add_f32 v26, v26, v27
  s_nop 1
  v_add_f32_dpp v26, v26, v26 quad_perm:[1,0,3,2] row_mask:0xf bank_mask:0xf
  s_nop 1
  v_add_f32_dpp v26, v26, v26 quad_perm:[2,3,0,1] row_mask:0xf bank_mask:0xf
  s_nop 1
  v_add_f32_dpp v26, v26, v26 row_half_mirror row_mask:0xf bank_mask:0xf
  v_mov_b32 v27, v26
  s_nop 1
  v_permlane16_swap_b32 v26, v27
  v_add_f32 v26, v26, v27
  v_mov_b32 v27, v26
  s_nop 1
  v_permlane32_swap_b32 v26, v27
  v_add_f32 v26, v26, v27
  v_mul_f32 v26, 0x3b124925, v26
  v_cvt_pk_bf16_f32 v27, v28, v26
  v_lshlrev_b32 v28, 16, v27
  v_and_b32 v27, 0xffff0000, v27
  v_add_f32 v27, 0x3727c5ac, v27
  v_cvt_pk_bf16_f32 v27, v27, v27
  v_lshlrev_b32 v27, 16, v27
  v_sqrt_f32 v27, v27
  s_nop 0
  v_cvt_pk_bf16_f32 v27, v27, v27
  v_lshlrev_b32 v27, 16, v27
  v_rcp_f32 v29, v27
  v_lshlrev_b32 v200, 16, v136
  v_and_b32 v201, 0xffff0000, v136
  v_lshlrev_b32 v202, 16, v137
  v_and_b32 v203, 0xffff0000, v137
  v_lshlrev_b32 v204, 16, v138
  v_and_b32 v205, 0xffff0000, v138
  v_lshlrev_b32 v206, 16, v139
  v_and_b32 v207, 0xffff0000, v139
  v_lshlrev_b32 v208, 16, v140
  v_and_b32 v209, 0xffff0000, v140
  v_lshlrev_b32 v210, 16, v141
  v_and_b32 v211, 0xffff0000, v141
  v_lshlrev_b32 v212, 16, v142
  v_and_b32 v213, 0xffff0000, v142
  v_sub_f32 v200, v200, v28
  v_sub_f32 v201, v201, v28
  v_sub_f32 v202, v202, v28
  v_sub_f32 v203, v203, v28
  v_sub_f32 v204, v204, v28
  v_sub_f32 v205, v205, v28
  v_sub_f32 v206, v206, v28
  v_sub_f32 v207, v207, v28
  v_sub_f32 v208, v208, v28
  v_sub_f32 v209, v209, v28
  v_sub_f32 v210, v210, v28
  v_sub_f32 v211, v211, v28
  v_sub_f32 v212, v212, v28
  v_sub_f32 v213, v213, v28
  v_cvt_pk_bf16_f32 v136, v200, v201
  v_cvt_pk_bf16_f32 v137, v202, v203
  v_cvt_pk_bf16_f32 v138, v204, v205
  v_cvt_pk_bf16_f32 v139, v206, v207
  v_cvt_pk_bf16_f32 v140, v208, v209
  v_cvt_pk_bf16_f32 v141, v210, v211
  v_cvt_pk_bf16_f32 v142, v212, v213
  v_lshlrev_b32 v200, 16, v136
  v_and_b32 v201, 0xffff0000, v136
  v_lshlrev_b32 v202, 16, v137
  v_and_b32 v203, 0xffff0000, v137
  v_lshlrev_b32 v204, 16, v138
  v_and_b32 v205, 0xffff0000, v138
  v_lshlrev_b32 v206, 16, v139
  v_and_b32 v207, 0xffff0000, v139
  v_lshlrev_b32 v208, 16, v140
  v_and_b32 v209, 0xffff0000, v140
  v_lshlrev_b32 v210, 16, v141
  v_and_b32 v211, 0xffff0000, v141
  v_lshlrev_b32 v212, 16, v142
  v_and_b32 v213, 0xffff0000, v142
  v_mul_f32 v200, v200, v29
  v_mul_f32 v201, v201, v29
  v_mul_f32 v202, v202, v29
  v_mul_f32 v203, v203, v29
  v_mul_f32 v204, v204, v29
  v_mul_f32 v205, v205, v29
  v_mul_f32 v206, v206, v29
  v_mul_f32 v207, v207, v29
  v_mul_f32 v208, v208, v29
  v_mul_f32 v209, v209, v29
  v_mul_f32 v210, v210, v29
  v_mul_f32 v211, v211, v29
  v_mul_f32 v212, v212, v29
  v_mul_f32 v213, v213, v29
  v_cvt_pk_bf16_f32 v216, v200, v200
  v_cvt_pk_bf16_f32 v217, v201, v201
  v_cvt_pk_bf16_f32 v218, v202, v202
  v_cvt_pk_bf16_f32 v219, v203, v203
  v_cvt_pk_bf16_f32 v220, v204, v204
  v_cvt_pk_bf16_f32 v221, v205, v205
  v_cvt_pk_bf16_f32 v222, v206, v206
  v_cvt_pk_bf16_f32 v223, v207, v207
  v_cvt_pk_bf16_f32 v224, v208, v208
  v_cvt_pk_bf16_f32 v225, v209, v209
  v_cvt_pk_bf16_f32 v226, v210, v210
  v_cvt_pk_bf16_f32 v227, v211, v211
  v_cvt_pk_bf16_f32 v228, v212, v212
  v_cvt_pk_bf16_f32 v229, v213, v213
  v_and_b32 v64, v216, v12
  v_and_b32 v65, v216, v13
  v_and_b32 v66, v216, v14
  v_and_b32 v67, v216, v15
  v_and_b32 v68, v217, v12
  v_and_b32 v69, v217, v13
  v_and_b32 v70, v217, v14
  v_and_b32 v71, v217, v15
  v_and_b32 v72, v218, v12
  v_and_b32 v73, v218, v13
  v_and_b32 v74, v218, v14
  v_and_b32 v75, v218, v15
  v_and_b32 v76, v219, v12
  v_and_b32 v77, v219, v13
  v_and_b32 v78, v219, v14
  v_and_b32 v79, v219, v15
  v_and_b32 v80, v220, v12
  v_and_b32 v81, v220, v13
  v_and_b32 v82, v220, v14
  v_and_b32 v83, v220, v15
  v_and_b32 v84, v221, v12
  v_and_b32 v85, v221, v13
  v_and_b32 v86, v221, v14
  v_and_b32 v87, v221, v15
  v_and_b32 v88, v222, v12
  v_and_b32 v89, v222, v13
  v_and_b32 v90, v222, v14
  v_and_b32 v91, v222, v15
  v_and_b32 v92, v223, v12
  v_and_b32 v93, v223, v13
  v_and_b32 v94, v223, v14
  v_and_b32 v95, v223, v15
  v_and_b32 v96, v224, v12
  v_and_b32 v97, v224, v13
  v_and_b32 v98, v224, v14
  v_and_b32 v99, v224, v15
  v_and_b32 v100, v225, v12
  v_and_b32 v101, v225, v13
  v_and_b32 v102, v225, v14
  v_and_b32 v103, v225, v15
  v_and_b32 v104, v226, v12
  v_and_b32 v105, v226, v13
  v_and_b32 v106, v226, v14
  v_and_b32 v107, v226, v15
  v_and_b32 v108, v227, v12
  v_and_b32 v109, v227, v13
  v_and_b32 v110, v227, v14
  v_and_b32 v111, v227, v15
  v_and_b32 v112, v228, v12
  v_and_b32 v113, v228, v13
  v_and_b32 v114, v228, v14
  v_and_b32 v115, v228, v15
  v_and_b32 v116, v229, v12
  v_and_b32 v117, v229, v13
  v_and_b32 v118, v229, v14
  v_and_b32 v119, v229, v15
  s_waitcnt vmcnt(13)
  v_mfma_f32_16x16x32_bf16 v[32:35], v[144:147], v[64:67], 0
  s_waitcnt vmcnt(12)
  v_mfma_f32_16x16x32_bf16 v[36:39], v[148:151], v[68:71], 0
  s_waitcnt vmcnt(11)
  v_mfma_f32_16x16x32_bf16 v[32:35], v[152:155], v[72:75], v[32:35]
  s_waitcnt vmcnt(10)
  v_mfma_f32_16x16x32_bf16 v[36:39], v[156:159], v[76:79], v[36:39]
  s_waitcnt vmcnt(9)
  v_mfma_f32_16x16x32_bf16 v[32:35], v[160:163], v[80:83], v[32:35]
  s_waitcnt vmcnt(8)
  v_mfma_f32_16x16x32_bf16 v[36:39], v[164:167], v[84:87], v[36:39]
  s_waitcnt vmcnt(7)
  v_mfma_f32_16x16x32_bf16 v[32:35], v[168:171], v[88:91], v[32:35]
  s_waitcnt vmcnt(6)
  v_mfma_f32_16x16x32_bf16 v[36:39], v[172:175], v[92:95], v[36:39]
  s_waitcnt vmcnt(5)
  v_mfma_f32_16x16x32_bf16 v[32:35], v[176:179], v[96:99], v[32:35]
  s_waitcnt vmcnt(4)
  v_mfma_f32_16x16x32_bf16 v[36:39], v[180:183], v[100:103], v[36:39]
  s_waitcnt vmcnt(3)
  v_mfma_f32_16x16x32_bf16 v[32:35], v[184:187], v[104:107], v[32:35]
  s_waitcnt vmcnt(2)
  v_mfma_f32_16x16x32_bf16 v[36:39], v[188:191], v[108:111], v[36:39]
  s_waitcnt vmcnt(1)
  v_mfma_f32_16x16x32_bf16 v[32:35], v[192:195], v[112:115], v[32:35]
  s_waitcnt vmcnt(0)
  v_mfma_f32_16x16x32_bf16 v[36:39], v[196:199], v[116:119], v[36:39]
  v_bfe_u32 v26, v1, 3, 1
  v_lshlrev_b32 v26, 13, v26
  v_lshrrev_b32 v27, 4, v1
  v_lshlrev_b32 v27, 8, v27
  v_and_b32 v28, 7, v1
  v_lshlrev_b32 v28, 5, v28
  v_add3_u32 v26, v26, v27, v28
  s_lshr_b32 s77, s2, 3
  s_lshl_b32 s77, s77, 14
  s_and_b32 s78, s2, 7
  s_lshl_b32 s78, s78, 10
  s_add_u32 s77, s77, s78
  s_add_u32 s77, s77, 1048576
  v_mov_b32 v49, s61
  v_mov_b32 v51, s61
  v_mov_b32 v53, s61
  v_mov_b32 v55, s61
  v_add_f32 v48, v32, v36
  v_add_f32 v50, v33, v37
  v_add_f32 v52, v34, v38
  v_add_f32 v54, v35, v39
  buffer_store_dwordx4 v[48:51], v26, s[52:55], s77 offen sc1
  buffer_store_dwordx4 v[52:55], v26, s[52:55], s77 offen offset:16 sc1
  v_lshlrev_b32 v30, 4, v1
  s_lshl_b32 s77, s60, 16
  s_lshl_b32 s78, s59, 13
  s_add_u32 s77, s77, s78
  s_add_u32 s77, s77, 1048576
  buffer_load_dwordx4 v[64:67], v2, s[40:43], s65 offen offset:0 nt
  buffer_load_dwordx4 v[68:71], v2, s[40:43], s65 offen offset:256 nt
  buffer_load_dwordx4 v[72:75], v2, s[40:43], s8 offen offset:2048 nt
  buffer_load_dwordx4 v[76:79], v2, s[40:43], s8 offen offset:2304 nt
  buffer_load_dwordx4 v[80:83], v3, s[44:47], s65 offen offset:0 nt
  buffer_load_dwordx4 v[84:87], v3, s[44:47], s65 offen offset:256 nt
  buffer_load_dwordx4 v[88:91], v3, s[44:47], s8 offen offset:2048 nt
  buffer_load_dwordx4 v[92:95], v3, s[44:47], s8 offen offset:2304 nt
  s_add_u32 s65, s65, 4096
  s_mov_b32 s8, s65
  buffer_load_dwordx4 v[96:99], v2, s[40:43], s65 offen offset:0 nt
  buffer_load_dwordx4 v[100:103], v2, s[40:43], s65 offen offset:256 nt
  buffer_load_dwordx4 v[104:107], v2, s[40:43], s8 offen offset:2048 nt
  buffer_load_dwordx4 v[108:111], v2, s[40:43], s8 offen offset:2304 nt
  buffer_load_dwordx4 v[112:115], v3, s[44:47], s65 offen offset:0 nt
  buffer_load_dwordx4 v[116:119], v3, s[44:47], s65 offen offset:256 nt
  buffer_load_dwordx4 v[120:123], v3, s[44:47], s8 offen offset:2048 nt
  buffer_load_dwordx4 v[124:127], v3, s[44:47], s8 offen offset:2304 nt
  s_add_u32 s65, s65, 4096
  s_mov_b32 s8, s65
  s_waitcnt vmcnt(8)
L_qg:
  s_add_u32 s78, s77, 0
  buffer_load_dwordx4 v[128:131], v30, s[52:55], s78 offen offset:0 sc1
  buffer_load_dwordx4 v[132:135], v30, s[52:55], s78 offen offset:1024 sc1
  buffer_load_dwordx4 v[136:139], v30, s[52:55], s78 offen offset:2048 sc1
  buffer_load_dwordx4 v[140:143], v30, s[52:55], s78 offen offset:3072 sc1
  s_add_u32 s78, s77, 4096
  buffer_load_dwordx4 v[144:147], v30, s[52:55], s78 offen offset:0 sc1
  buffer_load_dwordx4 v[148:151], v30, s[52:55], s78 offen offset:1024 sc1
  buffer_load_dwordx4 v[152:155], v30, s[52:55], s78 offen offset:2048 sc1
  buffer_load_dwordx4 v[156:159], v30, s[52:55], s78 offen offset:3072 sc1
  s_add_u32 s78, s77, 16384
  buffer_load_dwordx4 v[160:163], v30, s[52:55], s78 offen offset:0 sc1
  buffer_load_dwordx4 v[164:167], v30, s[52:55], s78 offen offset:1024 sc1
  buffer_load_dwordx4 v[168:171], v30, s[52:55], s78 offen offset:2048 sc1
  buffer_load_dwordx4 v[172:175], v30, s[52:55], s78 offen offset:3072 sc1
  s_add_u32 s78, s77, 20480
  buffer_load_dwordx4 v[176:179], v30, s[52:55], s78 offen offset:0 sc1
  buffer_load_dwordx4 v[180:183], v30, s[52:55], s78 offen offset:1024 sc1
  buffer_load_dwordx4 v[184:187], v30, s[52:55], s78 offen offset:2048 sc1
  buffer_load_dwordx4 v[188:191], v30, s[52:55], s78 offen offset:3072 sc1
  s_add_u32 s78, s77, 32768
  buffer_load_dwordx4 v[192:195], v30, s[52:55], s78 offen offset:0 sc1
  buffer_load_dwordx4 v[196:199], v30, s[52:55], s78 offen offset:1024 sc1
  buffer_load_dwordx4 v[200:203], v30, s[52:55], s78 offen offset:2048 sc1
  buffer_load_dwordx4 v[204:207], v30, s[52:55], s78 offen offset:3072 sc1
  s_add_u32 s78, s77, 36864
  buffer_load_dwordx4 v[208:211], v30, s[52:55], s78 offen offset:0 sc1
  buffer_load_dwordx4 v[212:215], v30, s[52:55], s78 offen offset:1024 sc1
  buffer_load_dwordx4 v[216:219], v30, s[52:55], s78 offen offset:2048 sc1
  buffer_load_dwordx4 v[220:223], v30, s[52:55], s78 offen offset:3072 sc1
  s_add_u32 s78, s77, 49152
  buffer_load_dwordx4 v[224:227], v30, s[52:55], s78 offen offset:0 sc1
  buffer_load_dwordx4 v[228:231], v30, s[52:55], s78 offen offset:1024 sc1
  buffer_load_dwordx4 v[232:235], v30, s[52:55], s78 offen offset:2048 sc1
  buffer_load_dwordx4 v[236:239], v30, s[52:55], s78 offen offset:3072 sc1
  s_add_u32 s78, s77, 53248
  buffer_load_dwordx4 v[240:243], v30, s[52:55], s78 offen offset:0 sc1
  buffer_load_dwordx4 v[244:247], v30, s[52:55], s78 offen offset:1024 sc1
  buffer_load_dwordx4 v[248:251], v30, s[52:55], s78 offen offset:2048 sc1
  buffer_load_dwordx4 v[252:255], v30, s[52:55], s78 offen offset:3072 sc1
  s_waitcnt vmcnt(0)
  v_min_u32 v26, v129, v131
  v_max_u32 v27, v129, v131
  v_min3_u32 v26, v26, v133, v135
  v_max3_u32 v27, v27, v133, v135
  v_min3_u32 v26, v26, v137, v139
  v_max3_u32 v27, v27, v137, v139
  v_min3_u32 v26, v26, v141, v143
  v_max3_u32 v27, v27, v141, v143
  v_min3_u32 v26, v26, v145, v147
  v_max3_u32 v27, v27, v145, v147
  v_min3_u32 v26, v26, v149, v151
  v_max3_u32 v27, v27, v149, v151
  v_min3_u32 v26, v26, v153, v155
  v_max3_u32 v27, v27, v153, v155
  v_min3_u32 v26, v26, v157, v159
  v_max3_u32 v27, v27, v157, v159
  v_min3_u32 v26, v26, v161, v163
  v_max3_u32 v27, v27, v161, v163
  v_min3_u32 v26, v26, v165, v167
  v_max3_u32 v27, v27, v165, v167
  v_min3_u32 v26, v26, v169, v171
  v_max3_u32 v27, v27, v169, v171
  v_min3_u32 v26, v26, v173, v175
  v_max3_u32 v27, v27, v173, v175
  v_min3_u32 v26, v26, v177, v179
  v_max3_u32 v27, v27, v177, v179
  v_min3_u32 v26, v26, v181, v183
  v_max3_u32 v27, v27, v181, v183
  v_min3_u32 v26, v26, v185, v187
  v_max3_u32 v27, v27, v185, v187
  v_min3_u32 v26, v26, v189, v191
  v_max3_u32 v27, v27, v189, v191
  v_min3_u32 v26, v26, v193, v195
  v_max3_u32 v27, v27, v193, v195
  v_min3_u32 v26, v26, v197, v199
  v_max3_u32 v27, v27, v197, v199
  v_min3_u32 v26, v26, v201, v203
  v_max3_u32 v27, v27, v201, v203
  v_min3_u32 v26, v26, v205, v207
  v_max3_u32 v27, v27, v205, v207
  v_min3_u32 v26, v26, v209, v211
  v_max3_u32 v27, v27, v209, v211
  v_min3_u32 v26, v26, v213, v215
  v_max3_u32 v27, v27, v213, v215
  v_min3_u32 v26, v26, v217, v219
  v_max3_u32 v27, v27, v217, v219
  v_min3_u32 v26, v26, v221, v223
  v_max3_u32 v27, v27, v221, v223
  v_min3_u32 v26, v26, v225, v227
  v_max3_u32 v27, v27, v225, v227
  v_min3_u32 v26, v26, v229, v231
  v_max3_u32 v27, v27, v229, v231
  v_min3_u32 v26, v26, v233, v235
  v_max3_u32 v27, v27, v233, v235
  v_min3_u32 v26, v26, v237, v239
  v_max3_u32 v27, v27, v237, v239
  v_min3_u32 v26, v26, v241, v243
  v_max3_u32 v27, v27, v241, v243
  v_min3_u32 v26, v26, v245, v247
  v_max3_u32 v27, v27, v245, v247
  v_min3_u32 v26, v26, v249, v251
  v_max3_u32 v27, v27, v249, v251
  v_min3_u32 v26, v26, v253, v255
  v_max3_u32 v27, v27, v253, v255
  v_cmp_ne_u32 vcc, s61, v26
  v_cmp_ne_u32 s[74:75], s61, v27
  s_nop 1
  s_or_b64 vcc, vcc, s[74:75]
  s_cbranch_scc0 L_qok
  s_add_u32 s76, s76, 1
  s_cmp_lt_u32 s76, 2097152
  s_cbranch_scc1 L_qg
  s_mov_b64 exec, -1
  v_mov_b32 v26, 32
  v_mov_b32 v27, 3735879680
  global_store_dword v26, v27, s[36:37]
  s_branch L_qok
L_qok:
  v_add_f32 v128, v128, v144
  v_add_f32 v130, v130, v146
  v_add_f32 v132, v132, v148
  v_add_f32 v134, v134, v150
  v_add_f32 v136, v136, v152
  v_add_f32 v138, v138, v154
  v_add_f32 v140, v140, v156
  v_add_f32 v142, v142, v158
  v_add_f32 v128, v128, v136
  v_add_f32 v130, v130, v138
  v_add_f32 v132, v132, v140
  v_add_f32 v134, v134, v142
  v_add_f32 v128, v128, v132
  v_add_f32 v130, v130, v134
  v_add_f32 v160, v160, v176
  v_add_f32 v162, v162, v178
  v_add_f32 v164, v164, v180
  v_add_f32 v166, v166, v182
  v_add_f32 v168, v168, v184
  v_add_f32 v170, v170, v186
  v_add_f32 v172, v172, v188
  v_add_f32 v174, v174, v190
  v_add_f32 v160, v160, v168
  v_add_f32 v162, v162, v170
  v_add_f32 v164, v164, v172
  v_add_f32 v166, v166, v174
  v_add_f32 v160, v160, v164
  v_add_f32 v162, v162, v166
  v_add_f32 v192, v192, v208
  v_add_f32 v194, v194, v210
  v_add_f32 v196, v196, v212
  v_add_f32 v198, v198, v214
  v_add_f32 v200, v200, v216
  v_add_f32 v202, v202, v218
  v_add_f32 v204, v204, v220
  v_add_f32 v206, v206, v222
  v_add_f32 v192, v192, v200
  v_add_f32 v194, v194, v202
  v_add_f32 v196, v196, v204
  v_add_f32 v198, v198, v206
  v_add_f32 v192, v192, v196
  v_add_f32 v194, v194, v198
  v_add_f32 v224, v224, v240
  v_add_f32 v226, v226, v242
  v_add_f32 v228, v228, v244
  v_add_f32 v230, v230, v246
  v_add_f32 v232, v232, v248
  v_add_f32 v234, v234, v250
  v_add_f32 v236, v236, v252
  v_add_f32 v238, v238, v254
  v_add_f32 v224, v224, v232
  v_add_f32 v226, v226, v234
  v_add_f32 v228, v228, v236
  v_add_f32 v230, v230, v238
  v_add_f32 v224, v224, v228
  v_add_f32 v226, v226, v230
  v_lshrrev_b32 v26, 4, v1
  v_lshlrev_b32 v26, 6, v26
  v_and_b32 v27, 1, v1
  v_lshlrev_b32 v27, 5, v27
  v_and_b32 v28, 14, v1
  v_add3_u32 v26, v26, v27, v28
  v_add_u32 v26, 132096, v26
  v_cvt_pk_bf16_f32 v48, v128, v130
  v_cvt_pk_bf16_f32 v49, v160, v162
  v_cvt_pk_bf16_f32 v50, v192, v194
  v_cvt_pk_bf16_f32 v51, v224, v226
  ds_write_b16 v26, v48 offset:0
  ds_write_b16_d16_hi v26, v48 offset:16
  ds_write_b16 v26, v49 offset:256
  ds_write_b16_d16_hi v26, v49 offset:272
  ds_write_b16 v26, v50 offset:512
  ds_write_b16_d16_hi v26, v50 offset:528
  ds_write_b16 v26, v51 offset:768
  ds_write_b16_d16_hi v26, v51 offset:784
  s_waitcnt lgkmcnt(0)
  s_barrier
  buffer_load_dwordx4 v[128:131], v2, s[40:43], s65 offen offset:0 nt
  buffer_load_dwordx4 v[132:135], v2, s[40:43], s65 offen offset:256 nt
  buffer_load_dwordx4 v[136:139], v2, s[40:43], s8 offen offset:2048 nt
  buffer_load_dwordx4 v[140:143], v2, s[40:43], s8 offen offset:2304 nt
  buffer_load_dwordx4 v[144:147], v3, s[44:47], s65 offen offset:0 nt
  buffer_load_dwordx4 v[148:151], v3, s[44:47], s65 offen offset:256 nt
  buffer_load_dwordx4 v[152:155], v3, s[44:47], s8 offen offset:2048 nt
  buffer_load_dwordx4 v[156:159], v3, s[44:47], s8 offen offset:2304 nt
  s_add_u32 s65, s65, 4096
  s_mov_b32 s8, s65
  buffer_load_dwordx4 v[160:163], v2, s[40:43], s65 offen offset:0 nt
  buffer_load_dwordx4 v[164:167], v2, s[40:43], s65 offen offset:256 nt
  buffer_load_dwordx4 v[168:171], v2, s[40:43], s8 offen offset:2048 nt
  buffer_load_dwordx4 v[172:175], v2, s[40:43], s8 offen offset:2304 nt
  buffer_load_dwordx4 v[176:179], v3, s[44:47], s65 offen offset:0 nt
  buffer_load_dwordx4 v[180:183], v3, s[44:47], s65 offen offset:256 nt
  buffer_load_dwordx4 v[184:187], v3, s[44:47], s8 offen offset:2048 nt
  buffer_load_dwordx4 v[188:191], v3, s[44:47], s8 offen offset:2304 nt
  s_add_u32 s65, s65, 4096
  s_mov_b32 s8, s65
  buffer_load_dwordx4 v[192:195], v2, s[40:43], s65 offen offset:0 nt
  buffer_load_dwordx4 v[196:199], v2, s[40:43], s65 offen offset:256 nt
  buffer_load_dwordx4 v[200:203], v2, s[40:43], s8 offen offset:2048 nt
  buffer_load_dwordx4 v[204:207], v2, s[40:43], s8 offen offset:2304 nt
  buffer_load_dwordx4 v[208:211], v3, s[44:47], s65 offen offset:0 nt
  buffer_load_dwordx4 v[212:215], v3, s[44:47], s65 offen offset:256 nt
  buffer_load_dwordx4 v[216:219], v3, s[44:47], s8 offen offset:2048 nt
  buffer_load_dwordx4 v[220:223], v3, s[44:47], s8 offen offset:2304 nt
  s_add_u32 s65, s65, 4096
  s_mov_b32 s8, s65
  buffer_load_dwordx4 v[224:227], v2, s[40:43], s65 offen offset:0 nt
  buffer_load_dwordx4 v[228:231], v2, s[40:43], s65 offen offset:256 nt
  buffer_load_dwordx4 v[232:235], v2, s[40:43], s8 offen offset:2048 nt
  buffer_load_dwordx4 v[236:239], v2, s[40:43], s8 offen offset:2304 nt
  buffer_load_dwordx4 v[240:243], v3, s[44:47], s65 offen offset:0 nt
  buffer_load_dwordx4 v[244:247], v3, s[44:47], s65 offen offset:256 nt
  buffer_load_dwordx4 v[248:251], v3, s[44:47], s8 offen offset:2048 nt
  buffer_load_dwordx4 v[252:255], v3, s[44:47], s8 offen offset:2304 nt
  s_mul_i32 s65, s58, 688128
  s_add_u32 s65, s65, 196608
  s_mov_b32 s8, s65
  s_setprio 0
L_qrdy:
  v_bfe_u32 v26, v1, 3, 1
  v_lshlrev_b32 v26, 9, v26
  v_lshrrev_b32 v27, 4, v1
  v_lshlrev_b32 v27, 6, v27
  v_and_b32 v28, 3, v1
  v_lshlrev_b32 v28, 4, v28
  v_add3_u32 v26, v26, v27, v28
  v_add_u32 v26, 132096, v26
  ds_read_b128 v[4:7], v26
  ds_read_b128 v[8:11], v26 offset:256
  s_waitcnt lgkmcnt(0)
  s_waitcnt vmcnt(40)
  v_mfma_f32_16x16x32_bf16 v[32:35], v[64:67], v[4:7], 0
  v_mfma_f32_16x16x32_bf16 v[36:39], v[72:75], v[4:7], 0
  v_mfma_f32_16x16x32_bf16 v[32:35], v[68:71], v[8:11], v[32:35]
  v_mfma_f32_16x16x32_bf16 v[36:39], v[76:79], v[8:11], v[36:39]
  buffer_load_dwordx4 v[64:67], v2, s[40:43], s65 offen offset:0 nt
  buffer_load_dwordx4 v[68:71], v2, s[40:43], s65 offen offset:256 nt
  buffer_load_dwordx4 v[72:75], v2, s[40:43], s8 offen offset:2048 nt
  buffer_load_dwordx4 v[76:79], v2, s[40:43], s8 offen offset:2304 nt
  s_nop 3
  v_mov_b32_dpp v26, v32 quad_perm:[0,0,0,0] row_mask:0xf bank_mask:0xf
  v_mov_b32_dpp v27, v36 quad_perm:[0,0,0,0] row_mask:0xf bank_mask:0xf
  v_mov_b32_dpp v28, v34 quad_perm:[2,2,2,2] row_mask:0xf bank_mask:0xf
  v_mov_b32_dpp v29, v38 quad_perm:[2,2,2,2] row_mask:0xf bank_mask:0xf
  v_add_f32_dpp v26, v33, v26 quad_perm:[1,1,1,1] row_mask:0xf bank_mask:0xf
  v_add_f32_dpp v27, v37, v27 quad_perm:[1,1,1,1] row_mask:0xf bank_mask:0xf
  v_add_f32_dpp v28, v35, v28 quad_perm:[3,3,3,3] row_mask:0xf bank_mask:0xf
  v_add_f32_dpp v29, v39, v29 quad_perm:[3,3,3,3] row_mask:0xf bank_mask:0xf
  v_add_f32 v26, v26, v28
  v_add_f32 v27, v27, v29
  v_cvt_pk_bf16_f32 v28, v26, v27
  v_lshlrev_b32 v26, 16, v28
  v_and_b32 v27, 0xffff0000, v28
  v_add_f32 v27, s9, v27
  v_max_f32 v28, v26, v27
  v_cmp_gt_f32 vcc, v28, v24
  s_cbranch_vccz L_keep_13
  v_mov_b32 v29, v28
  s_nop 1
  v_permlane16_swap_b32 v28, v29
  v_max_f32 v28, v28, v29
  v_mov_b32 v29, v28
  s_nop 1
  v_permlane32_swap_b32 v28, v29
  v_max_f32 v28, v28, v29
  v_max_f32 v28, v28, v24
  v_sub_f32 v29, v24, v28
  v_mul_f32 v29, s70, v29
  v_exp_f32 v29, v29
  v_mov_b32 v24, v28
  v_mul_f32 v16, v16, v29
  v_mul_f32 v17, v17, v29
  v_mul_f32 v18, v18, v29
  v_mul_f32 v19, v19, v29
  v_mul_f32 v20, v20, v29
  v_mul_f32 v21, v21, v29
  v_mul_f32 v22, v22, v29
  v_mul_f32 v23, v23, v29
  v_mul_f32 v25, v25, v29
L_keep_13:
  v_sub_f32 v26, v26, v24
  v_sub_f32 v27, v27, v24
  v_mul_f32 v26, s70, v26
  v_mul_f32 v27, s70, v27
  v_exp_f32 v26, v26
  v_exp_f32 v27, v27
  s_nop 0
  v_cvt_pk_bf16_f32 v28, v26, v26
  v_cvt_pk_bf16_f32 v29, v27, v27
  v_add_f32 v25, v25, v26
  v_and_b32 v40, v28, v12
  v_and_b32 v41, v28, v13
  v_and_b32 v42, v28, v14
  v_and_b32 v43, v28, v15
  v_and_b32 v44, v29, v12
  v_and_b32 v45, v29, v13
  v_and_b32 v46, v29, v14
  v_and_b32 v47, v29, v15
  v_add_f32 v25, v25, v27
  v_mfma_f32_16x16x32_bf16 v[16:19], v[80:83], v[40:43], v[16:19]
  v_mfma_f32_16x16x32_bf16 v[20:23], v[84:87], v[40:43], v[20:23]
  v_mfma_f32_16x16x32_bf16 v[16:19], v[88:91], v[44:47], v[16:19]
  v_mfma_f32_16x16x32_bf16 v[20:23], v[92:95], v[44:47], v[20:23]
  buffer_load_dwordx4 v[80:83], v3, s[44:47], s65 offen offset:0 nt
  buffer_load_dwordx4 v[84:87], v3, s[44:47], s65 offen offset:256 nt
  buffer_load_dwordx4 v[88:91], v3, s[44:47], s8 offen offset:2048 nt
  buffer_load_dwordx4 v[92:95], v3, s[44:47], s8 offen offset:2304 nt
  s_mov_b32 s9, s100
  s_add_u32 s65, s65, 32768
  s_mov_b32 s8, s65
  s_waitcnt vmcnt(40)
  v_mfma_f32_16x16x32_bf16 v[32:35], v[96:99], v[4:7], 0
  v_mfma_f32_16x16x32_bf16 v[36:39], v[104:107], v[4:7], 0
  v_mfma_f32_16x16x32_bf16 v[32:35], v[100:103], v[8:11], v[32:35]
  v_mfma_f32_16x16x32_bf16 v[36:39], v[108:111], v[8:11], v[36:39]
  buffer_load_dwordx4 v[96:99], v2, s[40:43], s65 offen offset:0 nt
  buffer_load_dwordx4 v[100:103], v2, s[40:43], s65 offen offset:256 nt
  buffer_load_dwordx4 v[104:107], v2, s[40:43], s8 offen offset:2048 nt
  buffer_load_dwordx4 v[108:111], v2, s[40:43], s8 offen offset:2304 nt
  s_nop 3
  v_mov_b32_dpp v26, v32 quad_perm:[0,0,0,0] row_mask:0xf bank_mask:0xf
  v_mov_b32_dpp v27, v36 quad_perm:[0,0,0,0] row_mask:0xf bank_mask:0xf
  v_mov_b32_dpp v28, v34 quad_perm:[2,2,2,2] row_mask:0xf bank_mask:0xf
  v_mov_b32_dpp v29, v38 quad_perm:[2,2,2,2] row_mask:0xf bank_mask:0xf
  v_add_f32_dpp v26, v33, v26 quad_perm:[1,1,1,1] row_mask:0xf bank_mask:0xf
  v_add_f32_dpp v27, v37, v27 quad_perm:[1,1,1,1] row_mask:0xf bank_mask:0xf
  v_add_f32_dpp v28, v35, v28 quad_perm:[3,3,3,3] row_mask:0xf bank_mask:0xf
  v_add_f32_dpp v29, v39, v29 quad_perm:[3,3,3,3] row_mask:0xf bank_mask:0xf
  v_add_f32 v26, v26, v28
  v_add_f32 v27, v27, v29
  v_cvt_pk_bf16_f32 v28, v26, v27
  v_lshlrev_b32 v26, 16, v28
  v_and_b32 v27, 0xffff0000, v28
  v_add_f32 v27, s10, v27
  v_max_f32 v28, v26, v27
  v_cmp_gt_f32 vcc, v28, v24
  s_cbranch_vccz L_keep_14
  v_mov_b32 v29, v28
  s_nop 1
  v_permlane16_swap_b32 v28, v29
  v_max_f32 v28, v28, v29
  v_mov_b32 v29, v28
  s_nop 1
  v_permlane32_swap_b32 v28, v29
  v_max_f32 v28, v28, v29
  v_max_f32 v28, v28, v24
  v_sub_f32 v29, v24, v28
  v_mul_f32 v29, s70, v29
  v_exp_f32 v29, v29
  v_mov_b32 v24, v28
  v_mul_f32 v16, v16, v29
  v_mul_f32 v17, v17, v29
  v_mul_f32 v18, v18, v29
  v_mul_f32 v19, v19, v29
  v_mul_f32 v20, v20, v29
  v_mul_f32 v21, v21, v29
  v_mul_f32 v22, v22, v29
  v_mul_f32 v23, v23, v29
  v_mul_f32 v25, v25, v29
L_keep_14:
  v_sub_f32 v26, v26, v24
  v_sub_f32 v27, v27, v24
  v_mul_f32 v26, s70, v26
  v_mul_f32 v27, s70, v27
  v_exp_f32 v26, v26
  v_exp_f32 v27, v27
  s_nop 0
  v_cvt_pk_bf16_f32 v28, v26, v26
  v_cvt_pk_bf16_f32 v29, v27, v27
  v_add_f32 v25, v25, v26
  v_and_b32 v40, v28, v12
  v_and_b32 v41, v28, v13
  v_and_b32 v42, v28, v14
  v_and_b32 v43, v28, v15
  v_and_b32 v44, v29, v12
  v_and_b32 v45, v29, v13
  v_and_b32 v46, v29, v14
  v_and_b32 v47, v29, v15
  v_add_f32 v25, v25, v27
  v_mfma_f32_16x16x32_bf16 v[16:19], v[112:115], v[40:43], v[16:19]
  v_mfma_f32_16x16x32_bf16 v[20:23], v[116:119], v[40:43], v[20:23]
  v_mfma_f32_16x16x32_bf16 v[16:19], v[120:123], v[44:47], v[16:19]
  v_mfma_f32_16x16x32_bf16 v[20:23], v[124:127], v[44:47], v[20:23]
  buffer_load_dwordx4 v[112:115], v3, s[44:47], s65 offen offset:0 nt
  buffer_load_dwordx4 v[116:119], v3, s[44:47], s65 offen offset:256 nt
  buffer_load_dwordx4 v[120:123], v3, s[44:47], s8 offen offset:2048 nt
  buffer_load_dwordx4 v[124:127], v3, s[44:47], s8 offen offset:2304 nt
  s_mov_b32 s10, s100
  s_add_u32 s65, s65, 32768
  s_mov_b32 s8, s65
  s_waitcnt vmcnt(40)
  v_mfma_f32_16x16x32_bf16 v[32:35], v[128:131], v[4:7], 0
  v_mfma_f32_16x16x32_bf16 v[36:39], v[136:139], v[4:7], 0
  v_mfma_f32_16x16x32_bf16 v[32:35], v[132:135], v[8:11], v[32:35]
  v_mfma_f32_16x16x32_bf16 v[36:39], v[140:143], v[8:11], v[36:39]
  buffer_load_dwordx4 v[128:131], v2, s[40:43], s65 offen offset:0 nt
  buffer_load_dwordx4 v[132:135], v2, s[40:43], s65 offen offset:256 nt
  buffer_load_dwordx4 v[136:139], v2, s[40:43], s8 offen offset:2048 nt
  buffer_load_dwordx4 v[140:143], v2, s[40:43], s8 offen offset:2304 nt
  s_nop 3
  v_mov_b32_dpp v26, v32 quad_perm:[0,0,0,0] row_mask:0xf bank_mask:0xf
  v_mov_b32_dpp v27, v36 quad_perm:[0,0,0,0] row_mask:0xf bank_mask:0xf
  v_mov_b32_dpp v28, v34 quad_perm:[2,2,2,2] row_mask:0xf bank_mask:0xf
  v_mov_b32_dpp v29, v38 quad_perm:[2,2,2,2] row_mask:0xf bank_mask:0xf
  v_add_f32_dpp v26, v33, v26 quad_perm:[1,1,1,1] row_mask:0xf bank_mask:0xf
  v_add_f32_dpp v27, v37, v27 quad_perm:[1,1,1,1] row_mask:0xf bank_mask:0xf
  v_add_f32_dpp v28, v35, v28 quad_perm:[3,3,3,3] row_mask:0xf bank_mask:0xf
  v_add_f32_dpp v29, v39, v29 quad_perm:[3,3,3,3] row_mask:0xf bank_mask:0xf
  v_add_f32 v26, v26, v28
  v_add_f32 v27, v27, v29
  v_cvt_pk_bf16_f32 v28, v26, v27
  v_lshlrev_b32 v26, 16, v28
  v_and_b32 v27, 0xffff0000, v28
  v_add_f32 v27, s11, v27
  v_max_f32 v28, v26, v27
  v_cmp_gt_f32 vcc, v28, v24
  s_cbranch_vccz L_keep_15
  v_mov_b32 v29, v28
  s_nop 1
  v_permlane16_swap_b32 v28, v29
  v_max_f32 v28, v28, v29
  v_mov_b32 v29, v28
  s_nop 1
  v_permlane32_swap_b32 v28, v29
  v_max_f32 v28, v28, v29
  v_max_f32 v28, v28, v24
  v_sub_f32 v29, v24, v28
  v_mul_f32 v29, s70, v29
  v_exp_f32 v29, v29
  v_mov_b32 v24, v28
  v_mul_f32 v16, v16, v29
  v_mul_f32 v17, v17, v29
  v_mul_f32 v18, v18, v29
  v_mul_f32 v19, v19, v29
  v_mul_f32 v20, v20, v29
  v_mul_f32 v21, v21, v29
  v_mul_f32 v22, v22, v29
  v_mul_f32 v23, v23, v29
  v_mul_f32 v25, v25, v29
L_keep_15:
  v_sub_f32 v26, v26, v24
  v_sub_f32 v27, v27, v24
  v_mul_f32 v26, s70, v26
  v_mul_f32 v27, s70, v27
  v_exp_f32 v26, v26
  v_exp_f32 v27, v27
  s_nop 0
  v_cvt_pk_bf16_f32 v28, v26, v26
  v_cvt_pk_bf16_f32 v29, v27, v27
  v_add_f32 v25, v25, v26
  v_and_b32 v40, v28, v12
  v_and_b32 v41, v28, v13
  v_and_b32 v42, v28, v14
  v_and_b32 v43, v28, v15
  v_and_b32 v44, v29, v12
  v_and_b32 v45, v29, v13
  v_and_b32 v46, v29, v14
  v_and_b32 v47, v29, v15
  v_add_f32 v25, v25, v27
  v_mfma_f32_16x16x32_bf16 v[16:19], v[144:147], v[40:43], v[16:19]
  v_mfma_f32_16x16x32_bf16 v[20:23], v[148:151], v[40:43], v[20:23]
  v_mfma_f32_16x16x32_bf16 v[16:19], v[152:155], v[44:47], v[16:19]
  v_mfma_f32_16x16x32_bf16 v[20:23], v[156:159], v[44:47], v[20:23]
  buffer_load_dwordx4 v[144:147], v3, s[44:47], s65 offen offset:0 nt
  buffer_load_dwordx4 v[148:151], v3, s[44:47], s65 offen offset:256 nt
  buffer_load_dwordx4 v[152:155], v3, s[44:47], s8 offen offset:2048 nt
  buffer_load_dwordx4 v[156:159], v3, s[44:47], s8 offen offset:2304 nt
  s_mov_b32 s11, s100
  s_add_u32 s65, s65, 32768
  s_mov_b32 s8, s65
  s_waitcnt vmcnt(40)
  v_mfma_f32_16x16x32_bf16 v[32:35], v[160:163], v[4:7], 0
  v_mfma_f32_16x16x32_bf16 v[36:39], v[168:171], v[4:7], 0
  v_mfma_f32_16x16x32_bf16 v[32:35], v[164:167], v[8:11], v[32:35]
  v_mfma_f32_16x16x32_bf16 v[36:39], v[172:175], v[8:11], v[36:39]
  s_nop 7
  v_mov_b32_dpp v26, v32 quad_perm:[0,0,0,0] row_mask:0xf bank_mask:0xf
  v_mov_b32_dpp v27, v36 quad_perm:[0,0,0,0] row_mask:0xf bank_mask:0xf
  v_mov_b32_dpp v28, v34 quad_perm:[2,2,2,2] row_mask:0xf bank_mask:0xf
  v_mov_b32_dpp v29, v38 quad_perm:[2,2,2,2] row_mask:0xf bank_mask:0xf
  v_add_f32_dpp v26, v33, v26 quad_perm:[1,1,1,1] row_mask:0xf bank_mask:0xf
  v_add_f32_dpp v27, v37, v27 quad_perm:[1,1,1,1] row_mask:0xf bank_mask:0xf
  v_add_f32_dpp v28, v35, v28 quad_perm:[3,3,3,3] row_mask:0xf bank_mask:0xf
  v_add_f32_dpp v29, v39, v29 quad_perm:[3,3,3,3] row_mask:0xf bank_mask:0xf
  v_add_f32 v26, v26, v28
  v_add_f32 v27, v27, v29
  v_cvt_pk_bf16_f32 v28, v26, v27
  v_lshlrev_b32 v26, 16, v28
  v_and_b32 v27, 0xffff0000, v28
  v_max_f32 v28, v26, v27
  v_cmp_gt_f32 vcc, v28, v24
  s_cbranch_vccz L_keep_16
  v_mov_b32 v29, v28
  s_nop 1
  v_permlane16_swap_b32 v28, v29
  v_max_f32 v28, v28, v29
  v_mov_b32 v29, v28
  s_nop 1
  v_permlane32_swap_b32 v28, v29
  v_max_f32 v28, v28, v29
  v_max_f32 v28, v28, v24
  v_sub_f32 v29, v24, v28
  v_mul_f32 v29, s70, v29
  v_exp_f32 v29, v29
  v_mov_b32 v24, v28
  v_mul_f32 v16, v16, v29
  v_mul_f32 v17, v17, v29
  v_mul_f32 v18, v18, v29
  v_mul_f32 v19, v19, v29
  v_mul_f32 v20, v20, v29
  v_mul_f32 v21, v21, v29
  v_mul_f32 v22, v22, v29
  v_mul_f32 v23, v23, v29
  v_mul_f32 v25, v25, v29
L_keep_16:
  v_sub_f32 v26, v26, v24
  v_sub_f32 v27, v27, v24
  v_mul_f32 v26, s70, v26
  v_mul_f32 v27, s70, v27
  v_exp_f32 v26, v26
  v_exp_f32 v27, v27
  s_nop 0
  v_cvt_pk_bf16_f32 v28, v26, v26
  v_cvt_pk_bf16_f32 v29, v27, v27
  v_add_f32 v25, v25, v26
  v_and_b32 v40, v28, v12
  v_and_b32 v41, v28, v13
  v_and_b32 v42, v28, v14
  v_and_b32 v43, v28, v15
  v_and_b32 v44, v29, v12
  v_and_b32 v45, v29, v13
  v_and_b32 v46, v29, v14
  v_and_b32 v47, v29, v15
  v_add_f32 v25, v25, v27
  v_mfma_f32_16x16x32_bf16 v[16:19], v[176:179], v[40:43], v[16:19]
  v_mfma_f32_16x16x32_bf16 v[20:23], v[180:183], v[40:43], v[20:23]
  v_mfma_f32_16x16x32_bf16 v[16:19], v[184:187], v[44:47], v[16:19]
  v_mfma_f32_16x16x32_bf16 v[20:23], v[188:191], v[44:47], v[20:23]
  s_waitcnt vmcnt(32)
  v_mfma_f32_16x16x32_bf16 v[32:35], v[192:195], v[4:7], 0
  v_mfma_f32_16x16x32_bf16 v[36:39], v[200:203], v[4:7], 0
  v_mfma_f32_16x16x32_bf16 v[32:35], v[196:199], v[8:11], v[32:35]
  v_mfma_f32_16x16x32_bf16 v[36:39], v[204:207], v[8:11], v[36:39]
  s_nop 7
  v_mov_b32_dpp v26, v32 quad_perm:[0,0,0,0] row_mask:0xf bank_mask:0xf
  v_mov_b32_dpp v27, v36 quad_perm:[0,0,0,0] row_mask:0xf bank_mask:0xf
  v_mov_b32_dpp v28, v34 quad_perm:[2,2,2,2] row_mask:0xf bank_mask:0xf
  v_mov_b32_dpp v29, v38 quad_perm:[2,2,2,2] row_mask:0xf bank_mask:0xf
  v_add_f32_dpp v26, v33, v26 quad_perm:[1,1,1,1] row_mask:0xf bank_mask:0xf
  v_add_f32_dpp v27, v37, v27 quad_perm:[1,1,1,1] row_mask:0xf bank_mask:0xf
  v_add_f32_dpp v28, v35, v28 quad_perm:[3,3,3,3] row_mask:0xf bank_mask:0xf
  v_add_f32_dpp v29, v39, v29 quad_perm:[3,3,3,3] row_mask:0xf bank_mask:0xf
  v_add_f32 v26, v26, v28
  v_add_f32 v27, v27, v29
  v_cvt_pk_bf16_f32 v28, v26, v27
  v_lshlrev_b32 v26, 16, v28
  v_and_b32 v27, 0xffff0000, v28
  v_max_f32 v28, v26, v27
  v_cmp_gt_f32 vcc, v28, v24
  s_cbranch_vccz L_keep_17
  v_mov_b32 v29, v28
  s_nop 1
  v_permlane16_swap_b32 v28, v29
  v_max_f32 v28, v28, v29
  v_mov_b32 v29, v28
  s_nop 1
  v_permlane32_swap_b32 v28, v29
  v_max_f32 v28, v28, v29
  v_max_f32 v28, v28, v24
  v_sub_f32 v29, v24, v28
  v_mul_f32 v29, s70, v29
  v_exp_f32 v29, v29
  v_mov_b32 v24, v28
  v_mul_f32 v16, v16, v29
  v_mul_f32 v17, v17, v29
  v_mul_f32 v18, v18, v29
  v_mul_f32 v19, v19, v29
  v_mul_f32 v20, v20, v29
  v_mul_f32 v21, v21, v29
  v_mul_f32 v22, v22, v29
  v_mul_f32 v23, v23, v29
  v_mul_f32 v25, v25, v29
L_keep_17:
  v_sub_f32 v26, v26, v24
  v_sub_f32 v27, v27, v24
  v_mul_f32 v26, s70, v26
  v_mul_f32 v27, s70, v27
  v_exp_f32 v26, v26
  v_exp_f32 v27, v27
  s_nop 0
  v_cvt_pk_bf16_f32 v28, v26, v26
  v_cvt_pk_bf16_f32 v29, v27, v27
  v_add_f32 v25, v25, v26
  v_and_b32 v40, v28, v12
  v_and_b32 v41, v28, v13
  v_and_b32 v42, v28, v14
  v_and_b32 v43, v28, v15
  v_and_b32 v44, v29, v12
  v_and_b32 v45, v29, v13
  v_and_b32 v46, v29, v14
  v_and_b32 v47, v29, v15
  v_add_f32 v25, v25, v27
  v_mfma_f32_16x16x32_bf16 v[16:19], v[208:211], v[40:43], v[16:19]
  v_mfma_f32_16x16x32_bf16 v[20:23], v[212:215], v[40:43], v[20:23]
  v_mfma_f32_16x16x32_bf16 v[16:19], v[216:219], v[44:47], v[16:19]
  v_mfma_f32_16x16x32_bf16 v[20:23], v[220:223], v[44:47], v[20:23]
  s_waitcnt vmcnt(24)
  v_mfma_f32_16x16x32_bf16 v[32:35], v[224:227], v[4:7], 0
  v_mfma_f32_16x16x32_bf16 v[36:39], v[232:235], v[4:7], 0
  v_mfma_f32_16x16x32_bf16 v[32:35], v[228:231], v[8:11], v[32:35]
  v_mfma_f32_16x16x32_bf16 v[36:39], v[236:239], v[8:11], v[36:39]
  s_nop 7
  v_mov_b32_dpp v26, v32 quad_perm:[0,0,0,0] row_mask:0xf bank_mask:0xf
  v_mov_b32_dpp v27, v36 quad_perm:[0,0,0,0] row_mask:0xf bank_mask:0xf
  v_mov_b32_dpp v28, v34 quad_perm:[2,2,2,2] row_mask:0xf bank_mask:0xf
  v_mov_b32_dpp v29, v38 quad_perm:[2,2,2,2] row_mask:0xf bank_mask:0xf
  v_add_f32_dpp v26, v33, v26 quad_perm:[1,1,1,1] row_mask:0xf bank_mask:0xf
  v_add_f32_dpp v27, v37, v27 quad_perm:[1,1,1,1] row_mask:0xf bank_mask:0xf
  v_add_f32_dpp v28, v35, v28 quad_perm:[3,3,3,3] row_mask:0xf bank_mask:0xf
  v_add_f32_dpp v29, v39, v29 quad_perm:[3,3,3,3] row_mask:0xf bank_mask:0xf
  v_add_f32 v26, v26, v28
  v_add_f32 v27, v27, v29
  v_cvt_pk_bf16_f32 v28, v26, v27
  v_lshlrev_b32 v26, 16, v28
  v_and_b32 v27, 0xffff0000, v28
  v_max_f32 v28, v26, v27
  v_cmp_gt_f32 vcc, v28, v24
  s_cbranch_vccz L_keep_18
  v_mov_b32 v29, v28
  s_nop 1
  v_permlane16_swap_b32 v28, v29
  v_max_f32 v28, v28, v29
  v_mov_b32 v29, v28
  s_nop 1
  v_permlane32_swap_b32 v28, v29
  v_max_f32 v28, v28, v29
  v_max_f32 v28, v28, v24
  v_sub_f32 v29, v24, v28
  v_mul_f32 v29, s70, v29
  v_exp_f32 v29, v29
  v_mov_b32 v24, v28
  v_mul_f32 v16, v16, v29
  v_mul_f32 v17, v17, v29
  v_mul_f32 v18, v18, v29
  v_mul_f32 v19, v19, v29
  v_mul_f32 v20, v20, v29
  v_mul_f32 v21, v21, v29
  v_mul_f32 v22, v22, v29
  v_mul_f32 v23, v23, v29
  v_mul_f32 v25, v25, v29
L_keep_18:
  v_sub_f32 v26, v26, v24
  v_sub_f32 v27, v27, v24
  v_mul_f32 v26, s70, v26
  v_mul_f32 v27, s70, v27
  v_exp_f32 v26, v26
  v_exp_f32 v27, v27
  s_nop 0
  v_cvt_pk_bf16_f32 v28, v26, v26
  v_cvt_pk_bf16_f32 v29, v27, v27
  v_add_f32 v25, v25, v26
  v_and_b32 v40, v28, v12
  v_and_b32 v41, v28, v13
  v_and_b32 v42, v28, v14
  v_and_b32 v43, v28, v15
  v_and_b32 v44, v29, v12
  v_and_b32 v45, v29, v13
  v_and_b32 v46, v29, v14
  v_and_b32 v47, v29, v15
  v_add_f32 v25, v25, v27
  v_mfma_f32_16x16x32_bf16 v[16:19], v[240:243], v[40:43], v[16:19]
  v_mfma_f32_16x16x32_bf16 v[20:23], v[244:247], v[40:43], v[20:23]
  v_mfma_f32_16x16x32_bf16 v[16:19], v[248:251], v[44:47], v[16:19]
  v_mfma_f32_16x16x32_bf16 v[20:23], v[252:255], v[44:47], v[20:23]
  s_mov_b32 s64, 8
  s_mov_b64 s[14:15], -1
  v_bfe_u32 v26, v1, 3, 1
  v_lshlrev_b32 v26, 3, v26
  s_lshl_b32 s77, s56, 4
  v_add_u32 v48, s77, v26
  s_lshl_b32 s77, s56, 11
  v_lshlrev_b32 v27, 5, v1
  v_add_u32 v49, s77, v27
  v_bfe_u32 v26, v0, 4, 1
  v_lshlrev_b32 v50, 3, v26
  v_lshlrev_b32 v51, 4, v0
  v_lshlrev_b32 v52, 14, v26
  v_lshrrev_b32 v27, 5, v0
  v_lshl_add_u32 v52, v27, 8, v52
  v_and_b32 v27, 15, v0
  v_lshl_add_u32 v52, v27, 4, v52
  s_lshl_b32 s77, s57, 5
  s_add_u32 s77, s77, s58
  s_lshl_b32 s98, s77, 10
  s_add_u32 s98, s98, 2097152
  s_mov_b32 s66, 256
  s_cmp_eq_u32 s68, 0
  s_cbranch_scc1 L_peel
  s_cmp_lg_u32 s56, 0
  s_cbranch_scc1 L_nochk
  s_mov_b32 s66, 0
  s_atomic_add s66, s[36:37], 0 glc
L_nochk:
  v_lshrrev_b32 v26, 4, v1
  v_and_b32 v27, 15, v1
  s_cmp_lg_u32 s68, 1
  s_cbranch_scc1 L_wffn
  s_mov_b32 s48, s24
  s_mov_b32 s49, s25
  s_mov_b32 s50, 3670016
  s_mov_b32 s51, 0x20000
  v_mul_u32_u24 v28, 896, v26
  v_lshl_add_u32 v28, v27, 4, v28
  s_lshl_b32 s77, s69, 8
  s_lshl_b32 s78, s56, 5
  s_add_u32 s77, s77, s78
  s_mul_i32 s77, s77, 896
  s_lshl_b32 s78, s97, 8
  s_add_u32 s77, s77, s78
  s_cmp_eq_u32 s97, 3
  s_cselect_b32 exec_lo, 0x00ff00ff, -1
  s_cselect_b32 exec_hi, 0x00ff00ff, -1
  buffer_load_dwordx4 v[160:163], v28, s[48:51], s77 offen nt
  s_add_u32 s77, s77, 3584
  buffer_load_dwordx4 v[164:167], v28, s[48:51], s77 offen nt
  s_add_u32 s77, s77, 3584
  buffer_load_dwordx4 v[168:171], v28, s[48:51], s77 offen nt
  s_add_u32 s77, s77, 3584
  buffer_load_dwordx4 v[172:175], v28, s[48:51], s77 offen nt
  s_add_u32 s77, s77, 3584
  buffer_load_dwordx4 v[176:179], v28, s[48:51], s77 offen nt
  s_add_u32 s77, s77, 3584
  buffer_load_dwordx4 v[180:183], v28, s[48:51], s77 offen nt
  s_add_u32 s77, s77, 3584
  buffer_load_dwordx4 v[184:187], v28, s[48:51], s77 offen nt
  s_add_u32 s77, s77, 3584
  buffer_load_dwordx4 v[188:191], v28, s[48:51], s77 offen nt
  s_mov_b64 exec, -1
  v_bfe_u32 v30, v1, 3, 1
  v_lshlrev_b32 v31, 8, v30
  v_and_b32 v54, 7, v1
  v_add_u32 v31, v31, v54
  v_lshlrev_b32 v31, 10, v31
  v_lshl_add_u32 v55, v26, 4, v31
  v_lshlrev_b32 v57, 9, v30
  v_lshl_add_u32 v57, v26, 4, v57
  s_lshl_b32 s77, s56, 6
  v_add_u32 v56, s77, v57
  v_lshlrev_b32 v58, 6, v30
  v_lshl_add_u32 v58, v26, 4, v58
  s_lshl_b32 s4, s97, 3
  s_add_u32 s4, s4, s56
  s_lshl_b32 s3, s69, 14
  s_lshl_b32 s78, s56, 7
  s_add_u32 s3, s3, s78
  s_add_u32 s3, s3, 2097152
  s_lshl_b32 s5, s69, 12
  s_lshl_b32 s78, s4, 7
  s_add_u32 s5, s5, s78
  s_add_u32 s5, s5, 2621440
  s_branch L_peel
L_wffn:
  v_mul_u32_u24 v28, 50176, v26
  v_and_b32 v29, 7, v1
  v_lshl_add_u32 v28, v29, 4, v28
  s_mul_i32 s77, s56, 200704
  s_lshl_b32 s78, s69, 7
  s_add_u32 s77, s77, s78
  s_mov_b32 s48, s28
  s_mov_b32 s49, s29
  s_mov_b32 s50, 1605632
  s_mov_b32 s51, 0x20000
  s_mov_b32 exec_lo, 0xff00ff
  s_mov_b32 exec_hi, 0xff00ff
  s_add_u32 s78, s77, 0
  buffer_load_dwordx4 v[160:163], v28, s[48:51], s78 offen nt
  s_add_u32 s78, s77, 3584
  buffer_load_dwordx4 v[164:167], v28, s[48:51], s78 offen nt
  s_add_u32 s78, s77, 7168
  buffer_load_dwordx4 v[168:171], v28, s[48:51], s78 offen nt
  s_add_u32 s78, s77, 10752
  buffer_load_dwordx4 v[172:175], v28, s[48:51], s78 offen nt
  s_add_u32 s78, s77, 14336
  buffer_load_dwordx4 v[176:179], v28, s[48:51], s78 offen nt
  s_add_u32 s78, s77, 17920
  buffer_load_dwordx4 v[180:183], v28, s[48:51], s78 offen nt
  s_add_u32 s78, s77, 21504
  buffer_load_dwordx4 v[184:187], v28, s[48:51], s78 offen nt
  s_add_u32 s78, s77, 25088
  buffer_load_dwordx4 v[188:191], v28, s[48:51], s78 offen nt
  s_add_u32 s78, s77, 28672
  buffer_load_dwordx4 v[192:195], v28, s[48:51], s78 offen nt
  s_add_u32 s78, s77, 32256
  buffer_load_dwordx4 v[196:199], v28, s[48:51], s78 offen nt
  s_add_u32 s78, s77, 35840
  buffer_load_dwordx4 v[200:203], v28, s[48:51], s78 offen nt
  s_add_u32 s78, s77, 39424
  buffer_load_dwordx4 v[204:207], v28, s[48:51], s78 offen nt
  s_add_u32 s78, s77, 43008
  buffer_load_dwordx4 v[208:211], v28, s[48:51], s78 offen nt
  s_add_u32 s78, s77, 46592
  buffer_load_dwordx4 v[212:215], v28, s[48:51], s78 offen nt
  s_mov_b32 s48, s30
  s_mov_b32 s49, s31
  s_mov_b32 s50, 1605632
  s_mov_b32 s51, 0x20000
  s_mov_b32 exec_lo, 0xff00ff00
  s_mov_b32 exec_hi, 0xff00ff00
  s_add_u32 s78, s77, 0
  buffer_load_dwordx4 v[160:163], v28, s[48:51], s78 offen nt
  s_add_u32 s78, s77, 3584
  buffer_load_dwordx4 v[164:167], v28, s[48:51], s78 offen nt
  s_add_u32 s78, s77, 7168
  buffer_load_dwordx4 v[168:171], v28, s[48:51], s78 offen nt
  s_add_u32 s78, s77, 10752
  buffer_load_dwordx4 v[172:175], v28, s[48:51], s78 offen nt
  s_add_u32 s78, s77, 14336
  buffer_load_dwordx4 v[176:179], v28, s[48:51], s78 offen nt
  s_add_u32 s78, s77, 17920
  buffer_load_dwordx4 v[180:183], v28, s[48:51], s78 offen nt
  s_add_u32 s78, s77, 21504
  buffer_load_dwordx4 v[184:187], v28, s[48:51], s78 offen nt
  s_add_u32 s78, s77, 25088
  buffer_load_dwordx4 v[188:191], v28, s[48:51], s78 offen nt
  s_add_u32 s78, s77, 28672
  buffer_load_dwordx4 v[192:195], v28, s[48:51], s78 offen nt
  s_add_u32 s78, s77, 32256
  buffer_load_dwordx4 v[196:199], v28, s[48:51], s78 offen nt
  s_add_u32 s78, s77, 35840
  buffer_load_dwordx4 v[200:203], v28, s[48:51], s78 offen nt
  s_add_u32 s78, s77, 39424
  buffer_load_dwordx4 v[204:207], v28, s[48:51], s78 offen nt
  s_add_u32 s78, s77, 43008
  buffer_load_dwordx4 v[208:211], v28, s[48:51], s78 offen nt
  s_add_u32 s78, s77, 46592
  buffer_load_dwordx4 v[212:215], v28, s[48:51], s78 offen nt
  s_mov_b64 exec, -1
  s_mov_b32 s48, s16
  s_mov_b32 s49, s17
  s_mov_b32 s50, 1792
  s_mov_b32 s51, 0x20000
  s_and_b32 s77, s56, 1
  s_lshl_b32 s77, s77, 6
  v_add_u32 v28, s77, v1
  s_bfe_u32 s78, s56, 0x10001
  s_mul_i32 s79, s78, 896
  v_lshlrev_b32 v55, 3, v28
  v_add_u32 v55, s79, v55
  v_mov_b32 v248, 0
  v_mov_b32 v249, 0
  s_mov_b32 s77, 112
  v_cmp_gt_u32 s[6:7], s77, v28
  s_nop 1
  s_mov_b64 exec, s[6:7]
  buffer_load_dwordx2 v[248:249], v55, s[48:51], 0 offen
  s_mov_b64 exec, -1
  v_lshrrev_b32 v54, 2, v28
  v_lshlrev_b32 v54, 7, v54
  v_and_b32 v29, 3, v28
  v_lshl_add_u32 v54, v29, 4, v54
  s_lshl_b32 s79, s78, 6
  v_add_u32 v54, s79, v54
  s_lshl_b32 s78, s78, 10
  v_lshlrev_b32 v56, 3, v28
  v_add_u32 v56, s78, v56
  v_bfe_u32 v30, v1, 3, 1
  v_mul_u32_u24 v57, 896, v30
  v_lshl_add_u32 v57, v26, 4, v57
  v_and_b32 v31, 7, v1
  v_lshl_add_u32 v31, v26, 3, v31
  v_lshlrev_b32 v31, 5, v31
  v_lshl_add_u32 v58, v30, 10, v31
  v_lshlrev_b32 v60, 7, v30
  v_lshl_add_u32 v59, v26, 2, v60
  s_lshl_b32 s77, s56, 4
  v_add_u32 v59, s77, v59
  v_lshl_add_u32 v60, v26, 4, v60
  v_lshlrev_b32 v61, 6, v30
  v_lshl_add_u32 v61, v26, 4, v61
  v_lshrrev_b32 v62, 3, v1
  v_lshlrev_b32 v62, 12, v62
  v_and_b32 v31, 7, v1
  v_lshl_add_u32 v62, v31, 4, v62
  v_bfe_u32 v63, v1, 2, 1
  v_mul_u32_u24 v63, 896, v63
  v_and_b32 v31, 3, v1
  v_lshl_add_u32 v63, v31, 3, v63
  s_lshl_b32 s77, s69, 5
  v_add_u32 v63, s77, v63
  s_lshl_b32 s5, s69, 12
  s_lshl_b32 s78, s56, 9
  s_add_u32 s5, s5, s78
  s_add_u32 s5, s5, 2686976
  s_lshl_b32 s4, s69, 7
  s_add_u32 s4, s4, 2686976
L_peel:
  s_waitcnt vmcnt(16)
  v_mfma_f32_16x16x32_bf16 v[32:35], v[64:67], v[4:7], 0
  v_mfma_f32_16x16x32_bf16 v[36:39], v[72:75], v[4:7], 0
  v_mfma_f32_16x16x32_bf16 v[32:35], v[68:71], v[8:11], v[32:35]
  v_mfma_f32_16x16x32_bf16 v[36:39], v[76:79], v[8:11], v[36:39]
  buffer_load_dwordx4 v[64:67], v2, s[40:43], s65 offen offset:0 nt
  buffer_load_dwordx4 v[68:71], v2, s[40:43], s65 offen offset:256 nt
  buffer_load_dwordx4 v[72:75], v2, s[40:43], s8 offen offset:2048 nt
  buffer_load_dwordx4 v[76:79], v2, s[40:43], s8 offen offset:2304 nt
  s_nop 3
  v_mov_b32_dpp v26, v32 quad_perm:[0,0,0,0] row_mask:0xf bank_mask:0xf
  v_mov_b32_dpp v27, v36 quad_perm:[0,0,0,0] row_mask:0xf bank_mask:0xf
  v_mov_b32_dpp v28, v34 quad_perm:[2,2,2,2] row_mask:0xf bank_mask:0xf
  v_mov_b32_dpp v29, v38 quad_perm:[2,2,2,2] row_mask:0xf bank_mask:0xf
  v_add_f32_dpp v26, v33, v26 quad_perm:[1,1,1,1] row_mask:0xf bank_mask:0xf
  v_add_f32_dpp v27, v37, v27 quad_perm:[1,1,1,1] row_mask:0xf bank_mask:0xf
  v_add_f32_dpp v28, v35, v28 quad_perm:[3,3,3,3] row_mask:0xf bank_mask:0xf
  v_add_f32_dpp v29, v39, v29 quad_perm:[3,3,3,3] row_mask:0xf bank_mask:0xf
  v_add_f32 v26, v26, v28
  v_add_f32 v27, v27, v29
  v_cvt_pk_bf16_f32 v28, v26, v27
  v_lshlrev_b32 v26, 16, v28
  v_and_b32 v27, 0xffff0000, v28
  v_add_f32 v27, s9, v27
  v_max_f32 v28, v26, v27
  v_cmp_gt_f32 vcc, v28, v24
  s_cbranch_vccz L_keep_19
  v_mov_b32 v29, v28
  s_nop 1
  v_permlane16_swap_b32 v28, v29
  v_max_f32 v28, v28, v29
  v_mov_b32 v29, v28
  s_nop 1
  v_permlane32_swap_b32 v28, v29
  v_max_f32 v28, v28, v29
  v_max_f32 v28, v28, v24
  v_sub_f32 v29, v24, v28
  v_mul_f32 v29, s70, v29
  v_exp_f32 v29, v29
  v_mov_b32 v24, v28
  v_mul_f32 v16, v16, v29
  v_mul_f32 v17, v17, v29
  v_mul_f32 v18, v18, v29
  v_mul_f32 v19, v19, v29
  v_mul_f32 v20, v20, v29
  v_mul_f32 v21, v21, v29
  v_mul_f32 v22, v22, v29
  v_mul_f32 v23, v23, v29
  v_mul_f32 v25, v25, v29
L_keep_19:
  v_sub_f32 v26, v26, v24
  v_sub_f32 v27, v27, v24
  v_mul_f32 v26, s70, v26
  v_mul_f32 v27, s70, v27
  v_exp_f32 v26, v26
  v_exp_f32 v27, v27
  s_nop 0
  v_cvt_pk_bf16_f32 v28, v26, v26
  v_cvt_pk_bf16_f32 v29, v27, v27
  v_add_f32 v25, v25, v26
  v_and_b32 v40, v28, v12
  v_and_b32 v41, v28, v13
  v_and_b32 v42, v28, v14
  v_and_b32 v43, v28, v15
  v_and_b32 v44, v29, v12
  v_and_b32 v45, v29, v13
  v_and_b32 v46, v29, v14
  v_and_b32 v47, v29, v15
  v_add_f32 v25, v25, v27
  v_mfma_f32_16x16x32_bf16 v[16:19], v[80:83], v[40:43], v[16:19]
  v_mfma_f32_16x16x32_bf16 v[20:23], v[84:87], v[40:43], v[20:23]
  v_mfma_f32_16x16x32_bf16 v[16:19], v[88:91], v[44:47], v[16:19]
  v_mfma_f32_16x16x32_bf16 v[20:23], v[92:95], v[44:47], v[20:23]
  buffer_load_dwordx4 v[80:83], v3, s[44:47], s65 offen offset:0 nt
  buffer_load_dwordx4 v[84:87], v3, s[44:47], s65 offen offset:256 nt
  buffer_load_dwordx4 v[88:91], v3, s[44:47], s8 offen offset:2048 nt
  buffer_load_dwordx4 v[92:95], v3, s[44:47], s8 offen offset:2304 nt
  s_mov_b32 s9, s100
  s_add_u32 s65, s65, 32768
  s_mov_b32 s8, s65
  s_barrier
  s_waitcnt vmcnt(16)
  v_mfma_f32_16x16x32_bf16 v[32:35], v[96:99], v[4:7], 0
  v_mfma_f32_16x16x32_bf16 v[36:39], v[104:107], v[4:7], 0
  v_mfma_f32_16x16x32_bf16 v[32:35], v[100:103], v[8:11], v[32:35]
  v_mfma_f32_16x16x32_bf16 v[36:39], v[108:111], v[8:11], v[36:39]
  buffer_load_dwordx4 v[96:99], v2, s[40:43], s65 offen offset:0 nt
  buffer_load_dwordx4 v[100:103], v2, s[40:43], s65 offen offset:256 nt
  buffer_load_dwordx4 v[104:107], v2, s[40:43], s8 offen offset:2048 nt
  buffer_load_dwordx4 v[108:111], v2, s[40:43], s8 offen offset:2304 nt
  s_nop 3
  v_mov_b32_dpp v26, v32 quad_perm:[0,0,0,0] row_mask:0xf bank_mask:0xf
  v_mov_b32_dpp v27, v36 quad_perm:[0,0,0,0] row_mask:0xf bank_mask:0xf
  v_mov_b32_dpp v28, v34 quad_perm:[2,2,2,2] row_mask:0xf bank_mask:0xf
  v_mov_b32_dpp v29, v38 quad_perm:[2,2,2,2] row_mask:0xf bank_mask:0xf
  v_add_f32_dpp v26, v33, v26 quad_perm:[1,1,1,1] row_mask:0xf bank_mask:0xf
  v_add_f32_dpp v27, v37, v27 quad_perm:[1,1,1,1] row_mask:0xf bank_mask:0xf
  v_add_f32_dpp v28, v35, v28 quad_perm:[3,3,3,3] row_mask:0xf bank_mask:0xf
  v_add_f32_dpp v29, v39, v29 quad_perm:[3,3,3,3] row_mask:0xf bank_mask:0xf
  v_add_f32 v26, v26, v28
  v_add_f32 v27, v27, v29
  v_cvt_pk_bf16_f32 v28, v26, v27
  v_lshlrev_b32 v26, 16, v28
  v_and_b32 v27, 0xffff0000, v28
  v_add_f32 v27, s10, v27
  v_max_f32 v28, v26, v27
  v_cmp_gt_f32 vcc, v28, v24
  s_cbranch_vccz L_keep_20
  v_mov_b32 v29, v28
  s_nop 1
  v_permlane16_swap_b32 v28, v29
  v_max_f32 v28, v28, v29
  v_mov_b32 v29, v28
  s_nop 1
  v_permlane32_swap_b32 v28, v29
  v_max_f32 v28, v28, v29
  v_max_f32 v28, v28, v24
  v_sub_f32 v29, v24, v28
  v_mul_f32 v29, s70, v29
  v_exp_f32 v29, v29
  v_mov_b32 v24, v28
  v_mul_f32 v16, v16, v29
  v_mul_f32 v17, v17, v29
  v_mul_f32 v18, v18, v29
  v_mul_f32 v19, v19, v29
  v_mul_f32 v20, v20, v29
  v_mul_f32 v21, v21, v29
  v_mul_f32 v22, v22, v29
  v_mul_f32 v23, v23, v29
  v_mul_f32 v25, v25, v29
L_keep_20:
  v_sub_f32 v26, v26, v24
  v_sub_f32 v27, v27, v24
  v_mul_f32 v26, s70, v26
  v_mul_f32 v27, s70, v27
  v_exp_f32 v26, v26
  v_exp_f32 v27, v27
  s_nop 0
  v_cvt_pk_bf16_f32 v28, v26, v26
  v_cvt_pk_bf16_f32 v29, v27, v27
  v_add_f32 v25, v25, v26
  v_and_b32 v40, v28, v12
  v_and_b32 v41, v28, v13
  v_and_b32 v42, v28, v14
  v_and_b32 v43, v28, v15
  v_and_b32 v44, v29, v12
  v_and_b32 v45, v29, v13
  v_and_b32 v46, v29, v14
  v_and_b32 v47, v29, v15
  v_add_f32 v25, v25, v27
  v_mfma_f32_16x16x32_bf16 v[16:19], v[112:115], v[40:43], v[16:19]
  v_mfma_f32_16x16x32_bf16 v[20:23], v[116:119], v[40:43], v[20:23]
  v_mfma_f32_16x16x32_bf16 v[16:19], v[120:123], v[44:47], v[16:19]
  v_mfma_f32_16x16x32_bf16 v[20:23], v[124:127], v[44:47], v[20:23]
  buffer_load_dwordx4 v[112:115], v3, s[44:47], s65 offen offset:0 nt
  buffer_load_dwordx4 v[116:119], v3, s[44:47], s65 offen offset:256 nt
  buffer_load_dwordx4 v[120:123], v3, s[44:47], s8 offen offset:2048 nt
  buffer_load_dwordx4 v[124:127], v3, s[44:47], s8 offen offset:2304 nt
  s_mov_b32 s10, s100
  s_add_u32 s65, s65, 32768
  s_mov_b32 s8, s65
  s_barrier
  s_waitcnt vmcnt(16)
  v_mfma_f32_16x16x32_bf16 v[32:35], v[128:131], v[4:7], 0
  v_mfma_f32_16x16x32_bf16 v[36:39], v[136:139], v[4:7], 0
  v_mfma_f32_16x16x32_bf16 v[32:35], v[132:135], v[8:11], v[32:35]
  v_mfma_f32_16x16x32_bf16 v[36:39], v[140:143], v[8:11], v[36:39]
  buffer_load_dwordx4 v[128:131], v2, s[40:43], s65 offen offset:0 nt
  buffer_load_dwordx4 v[132:135], v2, s[40:43], s65 offen offset:256 nt
  buffer_load_dwordx4 v[136:139], v2, s[40:43], s8 offen offset:2048 nt
  buffer_load_dwordx4 v[140:143], v2, s[40:43], s8 offen offset:2304 nt
  s_nop 3
  v_mov_b32_dpp v26, v32 quad_perm:[0,0,0,0] row_mask:0xf bank_mask:0xf
  v_mov_b32_dpp v27, v36 quad_perm:[0,0,0,0] row_mask:0xf bank_mask:0xf
  v_mov_b32_dpp v28, v34 quad_perm:[2,2,2,2] row_mask:0xf bank_mask:0xf
  v_mov_b32_dpp v29, v38 quad_perm:[2,2,2,2] row_mask:0xf bank_mask:0xf
  v_add_f32_dpp v26, v33, v26 quad_perm:[1,1,1,1] row_mask:0xf bank_mask:0xf
  v_add_f32_dpp v27, v37, v27 quad_perm:[1,1,1,1] row_mask:0xf bank_mask:0xf
  v_add_f32_dpp v28, v35, v28 quad_perm:[3,3,3,3] row_mask:0xf bank_mask:0xf
  v_add_f32_dpp v29, v39, v29 quad_perm:[3,3,3,3] row_mask:0xf bank_mask:0xf
  v_add_f32 v26, v26, v28
  v_add_f32 v27, v27, v29
  v_cvt_pk_bf16_f32 v28, v26, v27
  v_lshlrev_b32 v26, 16, v28
  v_and_b32 v27, 0xffff0000, v28
  v_add_f32 v27, s11, v27
  v_max_f32 v28, v26, v27
  v_cmp_gt_f32 vcc, v28, v24
  s_cbranch_vccz L_keep_21
  v_mov_b32 v29, v28
  s_nop 1
  v_permlane16_swap_b32 v28, v29
  v_max_f32 v28, v28, v29
  v_mov_b32 v29, v28
  s_nop 1
  v_permlane32_swap_b32 v28, v29
  v_max_f32 v28, v28, v29
  v_max_f32 v28, v28, v24
  v_sub_f32 v29, v24, v28
  v_mul_f32 v29, s70, v29
  v_exp_f32 v29, v29
  v_mov_b32 v24, v28
  v_mul_f32 v16, v16, v29
  v_mul_f32 v17, v17, v29
  v_mul_f32 v18, v18, v29
  v_mul_f32 v19, v19, v29
  v_mul_f32 v20, v20, v29
  v_mul_f32 v21, v21, v29
  v_mul_f32 v22, v22, v29
  v_mul_f32 v23, v23, v29
  v_mul_f32 v25, v25, v29
L_keep_21:
  v_sub_f32 v26, v26, v24
  v_sub_f32 v27, v27, v24
  v_mul_f32 v26, s70, v26
  v_mul_f32 v27, s70, v27
  v_exp_f32 v26, v26
  v_exp_f32 v27, v27
  s_nop 0
  v_cvt_pk_bf16_f32 v28, v26, v26
  v_cvt_pk_bf16_f32 v29, v27, v27
  v_add_f32 v25, v25, v26
  v_and_b32 v40, v28, v12
  v_and_b32 v41, v28, v13
  v_and_b32 v42, v28, v14
  v_and_b32 v43, v28, v15
  v_and_b32 v44, v29, v12
  v_and_b32 v45, v29, v13
  v_and_b32 v46, v29, v14
  v_and_b32 v47, v29, v15
  v_add_f32 v25, v25, v27
  v_mfma_f32_16x16x32_bf16 v[16:19], v[144:147], v[40:43], v[16:19]
  v_mfma_f32_16x16x32_bf16 v[20:23], v[148:151], v[40:43], v[20:23]
  v_mfma_f32_16x16x32_bf16 v[16:19], v[152:155], v[44:47], v[16:19]
  v_mfma_f32_16x16x32_bf16 v[20:23], v[156:159], v[44:47], v[20:23]
  buffer_load_dwordx4 v[144:147], v3, s[44:47], s65 offen offset:0 nt
  buffer_load_dwordx4 v[148:151], v3, s[44:47], s65 offen offset:256 nt
  buffer_load_dwordx4 v[152:155], v3, s[44:47], s8 offen offset:2048 nt
  buffer_load_dwordx4 v[156:159], v3, s[44:47], s8 offen offset:2304 nt
  s_mov_b32 s11, s100
  s_add_u32 s65, s65, 32768
  s_mov_b32 s8, s65
  s_barrier
  s_cmp_eq_u32 s68, 0
  s_cbranch_scc1 L_loop
  v_lshrrev_b32 v26, 4, v1
  v_and_b32 v27, 15, v1
  s_cmp_lg_u32 s68, 1
  s_cbranch_scc1 L_tffn
  v_and_b32 v28, 1, v26
  v_lshlrev_b32 v28, 4, v28
  v_lshrrev_b32 v29, 1, v26
  v_lshl_add_u32 v28, v29, 2, v28
  s_and_b32 s77, s56, 3
  s_lshl_b32 s77, s77, 6
  s_lshr_b32 s78, s56, 2
  s_lshl_b32 s78, s78, 3
  s_add_u32 s77, s77, s78
  v_add_u32 v28, s77, v28
  v_mul_u32_u24 v28, 272, v28
  v_lshl_add_u32 v28, v27, 4, v28
  v_lshrrev_b32 v29, 2, v27
  v_lshl_add_u32 v29, v26, 3, v29
  v_mul_u32_u24 v29, 272, v29
  v_and_b32 v30, 3, v1
  v_lshl_add_u32 v29, v30, 3, v29
  s_lshl_b32 s77, s56, 5
  v_add_u32 v29, s77, v29
  ds_write_b128 v28, v[160:163] offset:0
  ds_write_b128 v28, v[164:167] offset:8704
  ds_write_b128 v28, v[168:171] offset:272
  ds_write_b128 v28, v[172:175] offset:8976
  ds_write_b128 v28, v[176:179] offset:544
  ds_write_b128 v28, v[180:183] offset:9248
  ds_write_b128 v28, v[184:187] offset:816
  ds_write_b128 v28, v[188:191] offset:9520
  s_waitcnt lgkmcnt(0)
  s_barrier
  ds_read_b64_tr_b16 v[160:161], v29 offset:0
  ds_read_b64_tr_b16 v[162:163], v29 offset:1088
  ds_read_b64_tr_b16 v[164:165], v29 offset:8704
  ds_read_b64_tr_b16 v[166:167], v29 offset:9792
  ds_read_b64_tr_b16 v[168:169], v29 offset:17408
  ds_read_b64_tr_b16 v[170:171], v29 offset:18496
  ds_read_b64_tr_b16 v[172:173], v29 offset:26112
  ds_read_b64_tr_b16 v[174:175], v29 offset:27200
  ds_read_b64_tr_b16 v[176:177], v29 offset:34816
  ds_read_b64_tr_b16 v[178:179], v29 offset:35904
  ds_read_b64_tr_b16 v[180:181], v29 offset:43520
  ds_read_b64_tr_b16 v[182:183], v29 offset:44608
  ds_read_b64_tr_b16 v[184:185], v29 offset:52224
  ds_read_b64_tr_b16 v[186:187], v29 offset:53312
  ds_read_b64_tr_b16 v[188:189], v29 offset:60928
  ds_read_b64_tr_b16 v[190:191], v29 offset:62016
  s_branch L_chk
L_tffn:
  v_mul_u32_u24 v28, 3808, v26
  v_lshl_add_u32 v28, v27, 4, v28
  s_mul_i32 s77, s56, 15232
  v_add_u32 v28, s77, v28
  v_lshrrev_b32 v29, 2, v27
  v_lshl_add_u32 v29, v26, 3, v29
  v_mul_u32_u24 v29, 272, v29
  v_and_b32 v30, 2, v1
  v_lshl_add_u32 v29, v30, 6, v29
  v_and_b32 v30, 1, v1
  v_lshl_add_u32 v29, v30, 3, v29
  s_lshl_b32 s77, s56, 4
  v_add_u32 v29, s77, v29
  ds_write_b128 v28, v[160:163] offset:0
  ds_write_b128 v28, v[164:167] offset:272
  ds_write_b128 v28, v[168:171] offset:544
  ds_write_b128 v28, v[172:175] offset:816
  ds_write_b128 v28, v[176:179] offset:1088
  ds_write_b128 v28, v[180:183] offset:1360
  ds_write_b128 v28, v[184:187] offset:1632
  ds_write_b128 v28, v[188:191] offset:1904
  ds_write_b128 v28, v[192:195] offset:2176
  ds_write_b128 v28, v[196:199] offset:2448
  ds_write_b128 v28, v[200:203] offset:2720
  ds_write_b128 v28, v[204:207] offset:2992
  ds_write_b128 v28, v[208:211] offset:3264
  ds_write_b128 v28, v[212:215] offset:3536
  s_waitcnt lgkmcnt(0)
  s_barrier
  ds_read_b64_tr_b16 v[160:161], v29 offset:0
  ds_read_b64_tr_b16 v[162:163], v29 offset:1088
  ds_read_b64_tr_b16 v[164:165], v29 offset:8704
  ds_read_b64_tr_b16 v[166:167], v29 offset:9792
  ds_read_b64_tr_b16 v[168:169], v29 offset:17408
  ds_read_b64_tr_b16 v[170:171], v29 offset:18496
  ds_read_b64_tr_b16 v[172:173], v29 offset:26112
  ds_read_b64_tr_b16 v[174:175], v29 offset:27200
  ds_read_b64_tr_b16 v[176:177], v29 offset:34816
  ds_read_b64_tr_b16 v[178:179], v29 offset:35904
  ds_read_b64_tr_b16 v[180:181], v29 offset:43520
  ds_read_b64_tr_b16 v[182:183], v29 offset:44608
  ds_read_b64_tr_b16 v[184:185], v29 offset:52224
  ds_read_b64_tr_b16 v[186:187], v29 offset:53312
  v_add_u32 v29, 60928, v29
  ds_read_b64_tr_b16 v[188:189], v29 offset:0
  ds_read_b64_tr_b16 v[190:191], v29 offset:1088
  ds_read_b64_tr_b16 v[192:193], v29 offset:8704
  ds_read_b64_tr_b16 v[194:195], v29 offset:9792
  ds_read_b64_tr_b16 v[196:197], v29 offset:17408
  ds_read_b64_tr_b16 v[198:199], v29 offset:18496
  ds_read_b64_tr_b16 v[200:201], v29 offset:26112
  ds_read_b64_tr_b16 v[202:203], v29 offset:27200
  ds_read_b64_tr_b16 v[204:205], v29 offset:34816
  ds_read_b64_tr_b16 v[206:207], v29 offset:35904
  ds_read_b64_tr_b16 v[208:209], v29 offset:43520
  ds_read_b64_tr_b16 v[210:211], v29 offset:44608
  ds_read_b64_tr_b16 v[212:213], v29 offset:52224
  ds_read_b64_tr_b16 v[214:215], v29 offset:53312
  v_mov_b32 v40, 0x3f803f80
  v_mov_b32 v41, 0x3f803f80
  v_mov_b32 v42, 0x3f803f80
  v_mov_b32 v43, 0x3f803f80
  v_lshlrev_b32 v250, 16, v249
  v_and_b32 v251, 0xffff0000, v249
  v_and_b32 v249, 0xffff0000, v248
  v_lshlrev_b32 v248, 16, v248
  s_waitcnt lgkmcnt(0)
  v_mfma_f32_16x16x32_bf16 v[252:255], v[160:163], v[40:43], 0
  v_mfma_f32_16x16x32_bf16 v[252:255], v[164:167], v[40:43], v[252:255]
  v_mfma_f32_16x16x32_bf16 v[252:255], v[168:171], v[40:43], v[252:255]
  v_mfma_f32_16x16x32_bf16 v[252:255], v[172:175], v[40:43], v[252:255]
  v_mfma_f32_16x16x32_bf16 v[252:255], v[176:179], v[40:43], v[252:255]
  v_mfma_f32_16x16x32_bf16 v[252:255], v[180:183], v[40:43], v[252:255]
  v_mfma_f32_16x16x32_bf16 v[252:255], v[184:187], v[40:43], v[252:255]
  v_mfma_f32_16x16x32_bf16 v[252:255], v[188:191], v[40:43], v[252:255]
  v_mfma_f32_16x16x32_bf16 v[252:255], v[192:195], v[40:43], v[252:255]
  v_mfma_f32_16x16x32_bf16 v[252:255], v[196:199], v[40:43], v[252:255]
  v_mfma_f32_16x16x32_bf16 v[252:255], v[200:203], v[40:43], v[252:255]
  v_mfma_f32_16x16x32_bf16 v[252:255], v[204:207], v[40:43], v[252:255]
  v_mfma_f32_16x16x32_bf16 v[252:255], v[208:211], v[40:43], v[252:255]
  v_mfma_f32_16x16x32_bf16 v[252:255], v[212:215], v[40:43], v[252:255]
  s_nop 7
  v_permlane32_swap_b32 v252, v254
  v_permlane32_swap_b32 v253, v255
L_chk:
  s_waitcnt lgkmcnt(0)
  s_cmp_ge_u32 s66, 256
  s_cbranch_scc1 L_loop
  s_mov_b32 s66, 0
  s_atomic_add s66, s[36:37], 0 glc
  s_add_u32 s76, s76, 1
  s_cmp_lt_u32 s76, 2097152
  s_cbranch_scc1 L_chk
  s_mov_b64 exec, -1
  v_mov_b32 v26, 36
  v_mov_b32 v27, 3735879681
  global_store_dword v26, v27, s[36:37]
  s_branch L_loop
L_loop:
  s_or_b32 s77, s64, s56
  s_cbranch_scc1 L_ncl_22
  s_mov_b32 s66, 1
  s_cmp_lg_u32 s71, 0
  s_cbranch_scc1 L_ncl_22
  s_atomic_add s66, s[72:73], 0 glc
L_ncl_22:
  s_waitcnt vmcnt(16)
  v_mfma_f32_16x16x32_bf16 v[32:35], v[64:67], v[4:7], 0
  v_mfma_f32_16x16x32_bf16 v[36:39], v[72:75], v[4:7], 0
  v_mfma_f32_16x16x32_bf16 v[32:35], v[68:71], v[8:11], v[32:35]
  v_mfma_f32_16x16x32_bf16 v[36:39], v[76:79], v[8:11], v[36:39]
  buffer_load_dwordx4 v[64:67], v2, s[40:43], s65 offen offset:0 nt
  buffer_load_dwordx4 v[68:71], v2, s[40:43], s65 offen offset:256 nt
  buffer_load_dwordx4 v[72:75], v2, s[40:43], s8 offen offset:2048 nt
  buffer_load_dwordx4 v[76:79], v2, s[40:43], s8 offen offset:2304 nt
  s_nop 3
  v_mov_b32_dpp v26, v32 quad_perm:[0,0,0,0] row_mask:0xf bank_mask:0xf
  v_mov_b32_dpp v27, v36 quad_perm:[0,0,0,0] row_mask:0xf bank_mask:0xf
  v_mov_b32_dpp v28, v34 quad_perm:[2,2,2,2] row_mask:0xf bank_mask:0xf
  v_mov_b32_dpp v29, v38 quad_perm:[2,2,2,2] row_mask:0xf bank_mask:0xf
  v_add_f32_dpp v26, v33, v26 quad_perm:[1,1,1,1] row_mask:0xf bank_mask:0xf
  v_add_f32_dpp v27, v37, v27 quad_perm:[1,1,1,1] row_mask:0xf bank_mask:0xf
  v_add_f32_dpp v28, v35, v28 quad_perm:[3,3,3,3] row_mask:0xf bank_mask:0xf
  v_add_f32_dpp v29, v39, v29 quad_perm:[3,3,3,3] row_mask:0xf bank_mask:0xf
  v_add_f32 v26, v26, v28
  v_add_f32 v27, v27, v29
  v_cvt_pk_bf16_f32 v28, v26, v27
  v_lshlrev_b32 v26, 16, v28
  v_and_b32 v27, 0xffff0000, v28
  v_add_f32 v27, s9, v27
  v_max_f32 v28, v26, v27
  v_cmp_gt_f32 vcc, v28, v24
  s_cbranch_vccz L_keep_29
  v_mov_b32 v29, v28
  s_nop 1
  v_permlane16_swap_b32 v28, v29
  v_max_f32 v28, v28, v29
  v_mov_b32 v29, v28
  s_nop 1
  v_permlane32_swap_b32 v28, v29
  v_max_f32 v28, v28, v29
  v_max_f32 v28, v28, v24
  v_sub_f32 v29, v24, v28
  v_mul_f32 v29, s70, v29
  v_exp_f32 v29, v29
  v_mov_b32 v24, v28
  v_mul_f32 v16, v16, v29
  v_mul_f32 v17, v17, v29
  v_mul_f32 v18, v18, v29
  v_mul_f32 v19, v19, v29
  v_mul_f32 v20, v20, v29
  v_mul_f32 v21, v21, v29
  v_mul_f32 v22, v22, v29
  v_mul_f32 v23, v23, v29
  v_mul_f32 v25, v25, v29
L_keep_29:
  v_sub_f32 v26, v26, v24
  v_sub_f32 v27, v27, v24
  v_mul_f32 v26, s70, v26
  v_mul_f32 v27, s70, v27
  v_exp_f32 v26, v26
  v_exp_f32 v27, v27
  s_nop 0
  v_cvt_pk_bf16_f32 v28, v26, v26
  v_cvt_pk_bf16_f32 v29, v27, v27
  v_add_f32 v25, v25, v26
  v_and_b32 v40, v28, v12
  v_and_b32 v41, v28, v13
  v_and_b32 v42, v28, v14
  v_and_b32 v43, v28, v15
  v_and_b32 v44, v29, v12
  v_and_b32 v45, v29, v13
  v_and_b32 v46, v29, v14
  v_and_b32 v47, v29, v15
  v_add_f32 v25, v25, v27
  v_mfma_f32_16x16x32_bf16 v[16:19], v[80:83], v[40:43], v[16:19]
  v_mfma_f32_16x16x32_bf16 v[20:23], v[84:87], v[40:43], v[20:23]
  v_mfma_f32_16x16x32_bf16 v[16:19], v[88:91], v[44:47], v[16:19]
  v_mfma_f32_16x16x32_bf16 v[20:23], v[92:95], v[44:47], v[20:23]
  buffer_load_dwordx4 v[80:83], v3, s[44:47], s65 offen offset:0 nt
  buffer_load_dwordx4 v[84:87], v3, s[44:47], s65 offen offset:256 nt
  buffer_load_dwordx4 v[88:91], v3, s[44:47], s8 offen offset:2048 nt
  buffer_load_dwordx4 v[92:95], v3, s[44:47], s8 offen offset:2304 nt
  s_mov_b32 s9, s100
  s_cmp_eq_u32 s64, 0
  s_cbranch_scc1 L_dyn_23
  s_sub_u32 s64, s64, 1
  s_add_u32 s65, s65, 32768
  s_mov_b32 s8, s65
  s_barrier
  s_branch L_nx_25
L_dyn_23:
  s_cmp_lg_u32 s56, 0
  s_cbranch_scc1 L_wr_24
  s_cmp_lg_u32 s71, 0
  s_cbranch_scc1 L_stop_27
L_rec_26:
  s_waitcnt lgkmcnt(0)
  s_xor_b32 s66, s66, s62
  s_cmp_lt_u32 s66, 1024
  s_cbranch_scc1 L_cok_28
  s_mov_b32 s66, 1
  s_atomic_add s66, s[72:73], 0 glc
  s_add_u32 s76, s76, 1
  s_cmp_lt_u32 s76, 2097152
  s_cbranch_scc1 L_rec_26
  s_mov_b64 exec, -1
  v_mov_b32 v26, 40
  v_mov_b32 v27, 3735879682
  global_store_dword v26, v27, s[36:37]
  s_branch L_stop_27
L_stop_27:
  s_waitcnt lgkmcnt(0)
  s_mov_b32 s66, 1023
L_cok_28:
  s_cmp_ge_u32 s66, s99
  s_cselect_b32 s71, 1, 0
  v_mov_b32 v26, s66
  v_mov_b32 v27, s67
  ds_write_b32 v27, v26
  s_waitcnt lgkmcnt(0)
L_wr_24:
  s_barrier
  v_mov_b32 v27, s67
  ds_read_b32 v26, v27
  s_xor_b32 s67, s67, 4
  s_waitcnt lgkmcnt(0)
  v_readfirstlane_b32 s63, v26
  s_nop 3
  s_cmp_ge_u32 s63, 108
  s_cbranch_scc1 L_drain0
  s_cmp_ge_u32 s63, 10
  s_cbranch_scc1 L_t_30
  s_mul_i32 s65, s63, 229376
  s_add_u32 s65, s65, 11010048
  s_mov_b32 s8, s65
  s_mov_b32 s64, 6
  s_branch L_nx_25
L_t_30:
  s_cmp_ge_u32 s63, 20
  s_cbranch_scc1 L_t_31
  s_mul_i32 s65, s63, 131072
  s_add_u32 s65, s65, 11993088
  s_mov_b32 s8, s65
  s_mov_b32 s64, 3
  s_branch L_nx_25
L_t_31:
  s_cmp_ge_u32 s63, 30
  s_cbranch_scc1 L_t_32
  s_mul_i32 s65, s63, 65536
  s_add_u32 s65, s65, 13303808
  s_mov_b32 s8, s65
  s_mov_b32 s64, 1
  s_branch L_nx_25
L_t_32:
  s_cmp_ge_u32 s63, 44
  s_cbranch_scc1 L_t_33
  s_mul_i32 s65, s63, 32768
  s_add_u32 s65, s65, 14286848
  s_mov_b32 s8, s65
  s_mov_b32 s64, 0
  s_branch L_nx_25
L_t_33:
  s_sub_u32 s63, s63, 44
  s_lshr_b32 s65, s63, 1
  s_add_u32 s65, s65, 480
  s_lshl_b32 s65, s65, 15
  s_and_b32 s63, s63, 1
  s_lshl_b32 s63, s63, 11
  s_add_u32 s65, s65, s63
  s_mov_b32 s8, 0x40000000
  s_mov_b64 s[14:15], 0
  s_mov_b32 s100, 0xff7fffff
L_nx_25:
  s_or_b32 s77, s64, s56
  s_cbranch_scc1 L_ncl_34
  s_mov_b32 s66, 1
  s_cmp_lg_u32 s71, 0
  s_cbranch_scc1 L_ncl_34
  s_atomic_add s66, s[72:73], 0 glc
L_ncl_34:
  s_waitcnt vmcnt(16)
  v_mfma_f32_16x16x32_bf16 v[32:35], v[96:99], v[4:7], 0
  v_mfma_f32_16x16x32_bf16 v[36:39], v[104:107], v[4:7], 0
  v_mfma_f32_16x16x32_bf16 v[32:35], v[100:103], v[8:11], v[32:35]
  v_mfma_f32_16x16x32_bf16 v[36:39], v[108:111], v[8:11], v[36:39]
  buffer_load_dwordx4 v[96:99], v2, s[40:43], s65 offen offset:0 nt
  buffer_load_dwordx4 v[100:103], v2, s[40:43], s65 offen offset:256 nt
  buffer_load_dwordx4 v[104:107], v2, s[40:43], s8 offen offset:2048 nt
  buffer_load_dwordx4 v[108:111], v2, s[40:43], s8 offen offset:2304 nt
  s_nop 3
  v_mov_b32_dpp v26, v32 quad_perm:[0,0,0,0] row_mask:0xf bank_mask:0xf
  v_mov_b32_dpp v27, v36 quad_perm:[0,0,0,0] row_mask:0xf bank_mask:0xf
  v_mov_b32_dpp v28, v34 quad_perm:[2,2,2,2] row_mask:0xf bank_mask:0xf
  v_mov_b32_dpp v29, v38 quad_perm:[2,2,2,2] row_mask:0xf bank_mask:0xf
  v_add_f32_dpp v26, v33, v26 quad_perm:[1,1,1,1] row_mask:0xf bank_mask:0xf
  v_add_f32_dpp v27, v37, v27 quad_perm:[1,1,1,1] row_mask:0xf bank_mask:0xf
  v_add_f32_dpp v28, v35, v28 quad_perm:[3,3,3,3] row_mask:0xf bank_mask:0xf
  v_add_f32_dpp v29, v39, v29 quad_perm:[3,3,3,3] row_mask:0xf bank_mask:0xf
  v_add_f32 v26, v26, v28
  v_add_f32 v27, v27, v29
  v_cvt_pk_bf16_f32 v28, v26, v27
  v_lshlrev_b32 v26, 16, v28
  v_and_b32 v27, 0xffff0000, v28
  v_add_f32 v27, s10, v27
  v_max_f32 v28, v26, v27
  v_cmp_gt_f32 vcc, v28, v24
  s_cbranch_vccz L_keep_41
  v_mov_b32 v29, v28
  s_nop 1
  v_permlane16_swap_b32 v28, v29
  v_max_f32 v28, v28, v29
  v_mov_b32 v29, v28
  s_nop 1
  v_permlane32_swap_b32 v28, v29
  v_max_f32 v28, v28, v29
  v_max_f32 v28, v28, v24
  v_sub_f32 v29, v24, v28
  v_mul_f32 v29, s70, v29
  v_exp_f32 v29, v29
  v_mov_b32 v24, v28
  v_mul_f32 v16, v16, v29
  v_mul_f32 v17, v17, v29
  v_mul_f32 v18, v18, v29
  v_mul_f32 v19, v19, v29
  v_mul_f32 v20, v20, v29
  v_mul_f32 v21, v21, v29
  v_mul_f32 v22, v22, v29
  v_mul_f32 v23, v23, v29
  v_mul_f32 v25, v25, v29
L_keep_41:
  v_sub_f32 v26, v26, v24
  v_sub_f32 v27, v27, v24
  v_mul_f32 v26, s70, v26
  v_mul_f32 v27, s70, v27
  v_exp_f32 v26, v26
  v_exp_f32 v27, v27
  s_nop 0
  v_cvt_pk_bf16_f32 v28, v26, v26
  v_cvt_pk_bf16_f32 v29, v27, v27
  v_add_f32 v25, v25, v26
  v_and_b32 v40, v28, v12
  v_and_b32 v41, v28, v13
  v_and_b32 v42, v28, v14
  v_and_b32 v43, v28, v15
  v_and_b32 v44, v29, v12
  v_and_b32 v45, v29, v13
  v_and_b32 v46, v29, v14
  v_and_b32 v47, v29, v15
  v_add_f32 v25, v25, v27
  v_mfma_f32_16x16x32_bf16 v[16:19], v[112:115], v[40:43], v[16:19]
  v_mfma_f32_16x16x32_bf16 v[20:23], v[116:119], v[40:43], v[20:23]
  v_mfma_f32_16x16x32_bf16 v[16:19], v[120:123], v[44:47], v[16:19]
  v_mfma_f32_16x16x32_bf16 v[20:23], v[124:127], v[44:47], v[20:23]
  buffer_load_dwordx4 v[112:115], v3, s[44:47], s65 offen offset:0 nt
  buffer_load_dwordx4 v[116:119], v3, s[44:47], s65 offen offset:256 nt
  buffer_load_dwordx4 v[120:123], v3, s[44:47], s8 offen offset:2048 nt
  buffer_load_dwordx4 v[124:127], v3, s[44:47], s8 offen offset:2304 nt
  s_mov_b32 s10, s100
  s_cmp_eq_u32 s64, 0
  s_cbranch_scc1 L_dyn_35
  s_sub_u32 s64, s64, 1
  s_add_u32 s65, s65, 32768
  s_mov_b32 s8, s65
  s_barrier
  s_branch L_nx_37
L_dyn_35:
  s_cmp_lg_u32 s56, 0
  s_cbranch_scc1 L_wr_36
  s_cmp_lg_u32 s71, 0
  s_cbranch_scc1 L_stop_39
L_rec_38:
  s_waitcnt lgkmcnt(0)
  s_xor_b32 s66, s66, s62
  s_cmp_lt_u32 s66, 1024
  s_cbranch_scc1 L_cok_40
  s_mov_b32 s66, 1
  s_atomic_add s66, s[72:73], 0 glc
  s_add_u32 s76, s76, 1
  s_cmp_lt_u32 s76, 2097152
  s_cbranch_scc1 L_rec_38
  s_mov_b64 exec, -1
  v_mov_b32 v26, 40
  v_mov_b32 v27, 3735879682
  global_store_dword v26, v27, s[36:37]
  s_branch L_stop_39
L_stop_39:
  s_waitcnt lgkmcnt(0)
  s_mov_b32 s66, 1023
L_cok_40:
  s_cmp_ge_u32 s66, s99
  s_cselect_b32 s71, 1, 0
  v_mov_b32 v26, s66
  v_mov_b32 v27, s67
  ds_write_b32 v27, v26
  s_waitcnt lgkmcnt(0)
L_wr_36:
  s_barrier
  v_mov_b32 v27, s67
  ds_read_b32 v26, v27
  s_xor_b32 s67, s67, 4
  s_waitcnt lgkmcnt(0)
  v_readfirstlane_b32 s63, v26
  s_nop 3
  s_cmp_ge_u32 s63, 108
  s_cbranch_scc1 L_drain1
  s_cmp_ge_u32 s63, 10
  s_cbranch_scc1 L_t_42
  s_mul_i32 s65, s63, 229376
  s_add_u32 s65, s65, 11010048
  s_mov_b32 s8, s65
  s_mov_b32 s64, 6
  s_branch L_nx_37
L_t_42:
  s_cmp_ge_u32 s63, 20
  s_cbranch_scc1 L_t_43
  s_mul_i32 s65, s63, 131072
  s_add_u32 s65, s65, 11993088
  s_mov_b32 s8, s65
  s_mov_b32 s64, 3
  s_branch L_nx_37
L_t_43:
  s_cmp_ge_u32 s63, 30
  s_cbranch_scc1 L_t_44
  s_mul_i32 s65, s63, 65536
  s_add_u32 s65, s65, 13303808
  s_mov_b32 s8, s65
  s_mov_b32 s64, 1
  s_branch L_nx_37
L_t_44:
  s_cmp_ge_u32 s63, 44
  s_cbranch_scc1 L_t_45
  s_mul_i32 s65, s63, 32768
  s_add_u32 s65, s65, 14286848
  s_mov_b32 s8, s65
  s_mov_b32 s64, 0
  s_branch L_nx_37
L_t_45:
  s_sub_u32 s63, s63, 44
  s_lshr_b32 s65, s63, 1
  s_add_u32 s65, s65, 480
  s_lshl_b32 s65, s65, 15
  s_and_b32 s63, s63, 1
  s_lshl_b32 s63, s63, 11
  s_add_u32 s65, s65, s63
  s_mov_b32 s8, 0x40000000
  s_mov_b64 s[14:15], 0
  s_mov_b32 s100, 0xff7fffff
L_nx_37:
  s_or_b32 s77, s64, s56
  s_cbranch_scc1 L_ncl_46
  s_mov_b32 s66, 1
  s_cmp_lg_u32 s71, 0
  s_cbranch_scc1 L_ncl_46
  s_atomic_add s66, s[72:73], 0 glc
L_ncl_46:
  s_waitcnt vmcnt(16)
  v_mfma_f32_16x16x32_bf16 v[32:35], v[128:131], v[4:7], 0
  v_mfma_f32_16x16x32_bf16 v[36:39], v[136:139], v[4:7], 0
  v_mfma_f32_16x16x32_bf16 v[32:35], v[132:135], v[8:11], v[32:35]
  v_mfma_f32_16x16x32_bf16 v[36:39], v[140:143], v[8:11], v[36:39]
  buffer_load_dwordx4 v[128:131], v2, s[40:43], s65 offen offset:0 nt
  buffer_load_dwordx4 v[132:135], v2, s[40:43], s65 offen offset:256 nt
  buffer_load_dwordx4 v[136:139], v2, s[40:43], s8 offen offset:2048 nt
  buffer_load_dwordx4 v[140:143], v2, s[40:43], s8 offen offset:2304 nt
  s_nop 3
  v_mov_b32_dpp v26, v32 quad_perm:[0,0,0,0] row_mask:0xf bank_mask:0xf
  v_mov_b32_dpp v27, v36 quad_perm:[0,0,0,0] row_mask:0xf bank_mask:0xf
  v_mov_b32_dpp v28, v34 quad_perm:[2,2,2,2] row_mask:0xf bank_mask:0xf
  v_mov_b32_dpp v29, v38 quad_perm:[2,2,2,2] row_mask:0xf bank_mask:0xf
  v_add_f32_dpp v26, v33, v26 quad_perm:[1,1,1,1] row_mask:0xf bank_mask:0xf
  v_add_f32_dpp v27, v37, v27 quad_perm:[1,1,1,1] row_mask:0xf bank_mask:0xf
  v_add_f32_dpp v28, v35, v28 quad_perm:[3,3,3,3] row_mask:0xf bank_mask:0xf
  v_add_f32_dpp v29, v39, v29 quad_perm:[3,3,3,3] row_mask:0xf bank_mask:0xf
  v_add_f32 v26, v26, v28
  v_add_f32 v27, v27, v29
  v_cvt_pk_bf16_f32 v28, v26, v27
  v_lshlrev_b32 v26, 16, v28
  v_and_b32 v27, 0xffff0000, v28
  v_add_f32 v27, s11, v27
  v_max_f32 v28, v26, v27
  v_cmp_gt_f32 vcc, v28, v24
  s_cbranch_vccz L_keep_53
  v_mov_b32 v29, v28
  s_nop 1
  v_permlane16_swap_b32 v28, v29
  v_max_f32 v28, v28, v29
  v_mov_b32 v29, v28
  s_nop 1
  v_permlane32_swap_b32 v28, v29
  v_max_f32 v28, v28, v29
  v_max_f32 v28, v28, v24
  v_sub_f32 v29, v24, v28
  v_mul_f32 v29, s70, v29
  v_exp_f32 v29, v29
  v_mov_b32 v24, v28
  v_mul_f32 v16, v16, v29
  v_mul_f32 v17, v17, v29
  v_mul_f32 v18, v18, v29
  v_mul_f32 v19, v19, v29
  v_mul_f32 v20, v20, v29
  v_mul_f32 v21, v21, v29
  v_mul_f32 v22, v22, v29
  v_mul_f32 v23, v23, v29
  v_mul_f32 v25, v25, v29
L_keep_53:
  v_sub_f32 v26, v26, v24
  v_sub_f32 v27, v27, v24
  v_mul_f32 v26, s70, v26
  v_mul_f32 v27, s70, v27
  v_exp_f32 v26, v26
  v_exp_f32 v27, v27
  s_nop 0
  v_cvt_pk_bf16_f32 v28, v26, v26
  v_cvt_pk_bf16_f32 v29, v27, v27
  v_add_f32 v25, v25, v26
  v_and_b32 v40, v28, v12
  v_and_b32 v41, v28, v13
  v_and_b32 v42, v28, v14
  v_and_b32 v43, v28, v15
  v_and_b32 v44, v29, v12
  v_and_b32 v45, v29, v13
  v_and_b32 v46, v29, v14
  v_and_b32 v47, v29, v15
  v_add_f32 v25, v25, v27
  v_mfma_f32_16x16x32_bf16 v[16:19], v[144:147], v[40:43], v[16:19]
  v_mfma_f32_16x16x32_bf16 v[20:23], v[148:151], v[40:43], v[20:23]
  v_mfma_f32_16x16x32_bf16 v[16:19], v[152:155], v[44:47], v[16:19]
  v_mfma_f32_16x16x32_bf16 v[20:23], v[156:159], v[44:47], v[20:23]
  buffer_load_dwordx4 v[144:147], v3, s[44:47], s65 offen offset:0 nt
  buffer_load_dwordx4 v[148:151], v3, s[44:47], s65 offen offset:256 nt
  buffer_load_dwordx4 v[152:155], v3, s[44:47], s8 offen offset:2048 nt
  buffer_load_dwordx4 v[156:159], v3, s[44:47], s8 offen offset:2304 nt
  s_mov_b32 s11, s100
  s_cmp_eq_u32 s64, 0
  s_cbranch_scc1 L_dyn_47
  s_sub_u32 s64, s64, 1
  s_add_u32 s65, s65, 32768
  s_mov_b32 s8, s65
  s_barrier
  s_branch L_nx_49
L_dyn_47:
  s_cmp_lg_u32 s56, 0
  s_cbranch_scc1 L_wr_48
  s_cmp_lg_u32 s71, 0
  s_cbranch_scc1 L_stop_51
L_rec_50:
  s_waitcnt lgkmcnt(0)
  s_xor_b32 s66, s66, s62
  s_cmp_lt_u32 s66, 1024
  s_cbranch_scc1 L_cok_52
  s_mov_b32 s66, 1
  s_atomic_add s66, s[72:73], 0 glc
  s_add_u32 s76, s76, 1
  s_cmp_lt_u32 s76, 2097152
  s_cbranch_scc1 L_rec_50
  s_mov_b64 exec, -1
  v_mov_b32 v26, 40
  v_mov_b32 v27, 3735879682
  global_store_dword v26, v27, s[36:37]
  s_branch L_stop_51
L_stop_51:
  s_waitcnt lgkmcnt(0)
  s_mov_b32 s66, 1023
L_cok_52:
  s_cmp_ge_u32 s66, s99
  s_cselect_b32 s71, 1, 0
  v_mov_b32 v26, s66
  v_mov_b32 v27, s67
  ds_write_b32 v27, v26
  s_waitcnt lgkmcnt(0)
L_wr_48:
  s_barrier
  v_mov_b32 v27, s67
  ds_read_b32 v26, v27
  s_xor_b32 s67, s67, 4
  s_waitcnt lgkmcnt(0)
  v_readfirstlane_b32 s63, v26
  s_nop 3
  s_cmp_ge_u32 s63, 108
  s_cbranch_scc1 L_drain2
  s_cmp_ge_u32 s63, 10
  s_cbranch_scc1 L_t_54
  s_mul_i32 s65, s63, 229376
  s_add_u32 s65, s65, 11010048
  s_mov_b32 s8, s65
  s_mov_b32 s64, 6
  s_branch L_nx_49
L_t_54:
  s_cmp_ge_u32 s63, 20
  s_cbranch_scc1 L_t_55
  s_mul_i32 s65, s63, 131072
  s_add_u32 s65, s65, 11993088
  s_mov_b32 s8, s65
  s_mov_b32 s64, 3
  s_branch L_nx_49
L_t_55:
  s_cmp_ge_u32 s63, 30
  s_cbranch_scc1 L_t_56
  s_mul_i32 s65, s63, 65536
  s_add_u32 s65, s65, 13303808
  s_mov_b32 s8, s65
  s_mov_b32 s64, 1
  s_branch L_nx_49
L_t_56:
  s_cmp_ge_u32 s63, 44
  s_cbranch_scc1 L_t_57
  s_mul_i32 s65, s63, 32768
  s_add_u32 s65, s65, 14286848
  s_mov_b32 s8, s65
  s_mov_b32 s64, 0
  s_branch L_nx_49
L_t_57:
  s_sub_u32 s63, s63, 44
  s_lshr_b32 s65, s63, 1
  s_add_u32 s65, s65, 480
  s_lshl_b32 s65, s65, 15
  s_and_b32 s63, s63, 1
  s_lshl_b32 s63, s63, 11
  s_add_u32 s65, s65, s63
  s_mov_b32 s8, 0x40000000
  s_mov_b64 s[14:15], 0
  s_mov_b32 s100, 0xff7fffff
L_nx_49:
  s_branch L_loop
L_drain0:
  s_waitcnt vmcnt(16)
  v_mfma_f32_16x16x32_bf16 v[32:35], v[96:99], v[4:7], 0
  v_mfma_f32_16x16x32_bf16 v[36:39], v[104:107], v[4:7], 0
  v_mfma_f32_16x16x32_bf16 v[32:35], v[100:103], v[8:11], v[32:35]
  v_mfma_f32_16x16x32_bf16 v[36:39], v[108:111], v[8:11], v[36:39]
  s_nop 7
  v_mov_b32_dpp v26, v32 quad_perm:[0,0,0,0] row_mask:0xf bank_mask:0xf
  v_mov_b32_dpp v27, v36 quad_perm:[0,0,0,0] row_mask:0xf bank_mask:0xf
  v_mov_b32_dpp v28, v34 quad_perm:[2,2,2,2] row_mask:0xf bank_mask:0xf
  v_mov_b32_dpp v29, v38 quad_perm:[2,2,2,2] row_mask:0xf bank_mask:0xf
  v_add_f32_dpp v26, v33, v26 quad_perm:[1,1,1,1] row_mask:0xf bank_mask:0xf
  v_add_f32_dpp v27, v37, v27 quad_perm:[1,1,1,1] row_mask:0xf bank_mask:0xf
  v_add_f32_dpp v28, v35, v28 quad_perm:[3,3,3,3] row_mask:0xf bank_mask:0xf
  v_add_f32_dpp v29, v39, v29 quad_perm:[3,3,3,3] row_mask:0xf bank_mask:0xf
  v_add_f32 v26, v26, v28
  v_add_f32 v27, v27, v29
  v_cvt_pk_bf16_f32 v28, v26, v27
  v_lshlrev_b32 v26, 16, v28
  v_and_b32 v27, 0xffff0000, v28
  v_add_f32 v27, s10, v27
  v_max_f32 v28, v26, v27
  v_cmp_gt_f32 vcc, v28, v24
  s_cbranch_vccz L_keep_58
  v_mov_b32 v29, v28
  s_nop 1
  v_permlane16_swap_b32 v28, v29
  v_max_f32 v28, v28, v29
  v_mov_b32 v29, v28
  s_nop 1
  v_permlane32_swap_b32 v28, v29
  v_max_f32 v28, v28, v29
  v_max_f32 v28, v28, v24
  v_sub_f32 v29, v24, v28
  v_mul_f32 v29, s70, v29
  v_exp_f32 v29, v29
  v_mov_b32 v24, v28
  v_mul_f32 v16, v16, v29
  v_mul_f32 v17, v17, v29
  v_mul_f32 v18, v18, v29
  v_mul_f32 v19, v19, v29
  v_mul_f32 v20, v20, v29
  v_mul_f32 v21, v21, v29
  v_mul_f32 v22, v22, v29
  v_mul_f32 v23, v23, v29
  v_mul_f32 v25, v25, v29
L_keep_58:
  v_sub_f32 v26, v26, v24
  v_sub_f32 v27, v27, v24
  v_mul_f32 v26, s70, v26
  v_mul_f32 v27, s70, v27
  v_exp_f32 v26, v26
  v_exp_f32 v27, v27
  s_nop 0
  v_cvt_pk_bf16_f32 v28, v26, v26
  v_cvt_pk_bf16_f32 v29, v27, v27
  v_add_f32 v25, v25, v26
  v_and_b32 v40, v28, v12
  v_and_b32 v41, v28, v13
  v_and_b32 v42, v28, v14
  v_and_b32 v43, v28, v15
  v_and_b32 v44, v29, v12
  v_and_b32 v45, v29, v13
  v_and_b32 v46, v29, v14
  v_and_b32 v47, v29, v15
  v_add_f32 v25, v25, v27
  v_mfma_f32_16x16x32_bf16 v[16:19], v[112:115], v[40:43], v[16:19]
  v_mfma_f32_16x16x32_bf16 v[20:23], v[116:119], v[40:43], v[20:23]
  v_mfma_f32_16x16x32_bf16 v[16:19], v[120:123], v[44:47], v[16:19]
  v_mfma_f32_16x16x32_bf16 v[20:23], v[124:127], v[44:47], v[20:23]
  s_waitcnt vmcnt(8)
  v_mfma_f32_16x16x32_bf16 v[32:35], v[128:131], v[4:7], 0
  v_mfma_f32_16x16x32_bf16 v[36:39], v[136:139], v[4:7], 0
  v_mfma_f32_16x16x32_bf16 v[32:35], v[132:135], v[8:11], v[32:35]
  v_mfma_f32_16x16x32_bf16 v[36:39], v[140:143], v[8:11], v[36:39]
  s_nop 7
  v_mov_b32_dpp v26, v32 quad_perm:[0,0,0,0] row_mask:0xf bank_mask:0xf
  v_mov_b32_dpp v27, v36 quad_perm:[0,0,0,0] row_mask:0xf bank_mask:0xf
  v_mov_b32_dpp v28, v34 quad_perm:[2,2,2,2] row_mask:0xf bank_mask:0xf
  v_mov_b32_dpp v29, v38 quad_perm:[2,2,2,2] row_mask:0xf bank_mask:0xf
  v_add_f32_dpp v26, v33, v26 quad_perm:[1,1,1,1] row_mask:0xf bank_mask:0xf
  v_add_f32_dpp v27, v37, v27 quad_perm:[1,1,1,1] row_mask:0xf bank_mask:0xf
  v_add_f32_dpp v28, v35, v28 quad_perm:[3,3,3,3] row_mask:0xf bank_mask:0xf
  v_add_f32_dpp v29, v39, v29 quad_perm:[3,3,3,3] row_mask:0xf bank_mask:0xf
  v_add_f32 v26, v26, v28
  v_add_f32 v27, v27, v29
  v_cvt_pk_bf16_f32 v28, v26, v27
  v_lshlrev_b32 v26, 16, v28
  v_and_b32 v27, 0xffff0000, v28
  v_add_f32 v27, s11, v27
  v_max_f32 v28, v26, v27
  v_cmp_gt_f32 vcc, v28, v24
  s_cbranch_vccz L_keep_59
  v_mov_b32 v29, v28
  s_nop 1
  v_permlane16_swap_b32 v28, v29
  v_max_f32 v28, v28, v29
  v_mov_b32 v29, v28
  s_nop 1
  v_permlane32_swap_b32 v28, v29
  v_max_f32 v28, v28, v29
  v_max_f32 v28, v28, v24
  v_sub_f32 v29, v24, v28
  v_mul_f32 v29, s70, v29
  v_exp_f32 v29, v29
  v_mov_b32 v24, v28
  v_mul_f32 v16, v16, v29
  v_mul_f32 v17, v17, v29
  v_mul_f32 v18, v18, v29
  v_mul_f32 v19, v19, v29
  v_mul_f32 v20, v20, v29
  v_mul_f32 v21, v21, v29
  v_mul_f32 v22, v22, v29
  v_mul_f32 v23, v23, v29
  v_mul_f32 v25, v25, v29
L_keep_59:
  v_sub_f32 v26, v26, v24
  v_sub_f32 v27, v27, v24
  v_mul_f32 v26, s70, v26
  v_mul_f32 v27, s70, v27
  v_exp_f32 v26, v26
  v_exp_f32 v27, v27
  s_nop 0
  v_cvt_pk_bf16_f32 v28, v26, v26
  v_cvt_pk_bf16_f32 v29, v27, v27
  v_add_f32 v25, v25, v26
  v_and_b32 v40, v28, v12
  v_and_b32 v41, v28, v13
  v_and_b32 v42, v28, v14
  v_and_b32 v43, v28, v15
  v_and_b32 v44, v29, v12
  v_and_b32 v45, v29, v13
  v_and_b32 v46, v29, v14
  v_and_b32 v47, v29, v15
  v_add_f32 v25, v25, v27
  v_mfma_f32_16x16x32_bf16 v[16:19], v[144:147], v[40:43], v[16:19]
  v_mfma_f32_16x16x32_bf16 v[20:23], v[148:151], v[40:43], v[20:23]
  v_mfma_f32_16x16x32_bf16 v[16:19], v[152:155], v[44:47], v[16:19]
  v_mfma_f32_16x16x32_bf16 v[20:23], v[156:159], v[44:47], v[20:23]
  s_waitcnt vmcnt(0)
  v_mfma_f32_16x16x32_bf16 v[32:35], v[64:67], v[4:7], 0
  v_mfma_f32_16x16x32_bf16 v[36:39], v[72:75], v[4:7], 0
  v_mfma_f32_16x16x32_bf16 v[32:35], v[68:71], v[8:11], v[32:35]
  v_mfma_f32_16x16x32_bf16 v[36:39], v[76:79], v[8:11], v[36:39]
  s_nop 7
  v_mov_b32_dpp v26, v32 quad_perm:[0,0,0,0] row_mask:0xf bank_mask:0xf
  v_mov_b32_dpp v27, v36 quad_perm:[0,0,0,0] row_mask:0xf bank_mask:0xf
  v_mov_b32_dpp v28, v34 quad_perm:[2,2,2,2] row_mask:0xf bank_mask:0xf
  v_mov_b32_dpp v29, v38 quad_perm:[2,2,2,2] row_mask:0xf bank_mask:0xf
  v_add_f32_dpp v26, v33, v26 quad_perm:[1,1,1,1] row_mask:0xf bank_mask:0xf
  v_add_f32_dpp v27, v37, v27 quad_perm:[1,1,1,1] row_mask:0xf bank_mask:0xf
  v_add_f32_dpp v28, v35, v28 quad_perm:[3,3,3,3] row_mask:0xf bank_mask:0xf
  v_add_f32_dpp v29, v39, v29 quad_perm:[3,3,3,3] row_mask:0xf bank_mask:0xf
  v_add_f32 v26, v26, v28
  v_add_f32 v27, v27, v29
  v_cvt_pk_bf16_f32 v28, v26, v27
  v_lshlrev_b32 v26, 16, v28
  v_and_b32 v27, 0xffff0000, v28
  v_add_f32 v27, s9, v27
  v_max_f32 v28, v26, v27
  v_cmp_gt_f32 vcc, v28, v24
  s_cbranch_vccz L_keep_60
  v_mov_b32 v29, v28
  s_nop 1
  v_permlane16_swap_b32 v28, v29
  v_max_f32 v28, v28, v29
  v_mov_b32 v29, v28
  s_nop 1
  v_permlane32_swap_b32 v28, v29
  v_max_f32 v28, v28, v29
  v_max_f32 v28, v28, v24
  v_sub_f32 v29, v24, v28
  v_mul_f32 v29, s70, v29
  v_exp_f32 v29, v29
  v_mov_b32 v24, v28
  v_mul_f32 v16, v16, v29
  v_mul_f32 v17, v17, v29
  v_mul_f32 v18, v18, v29
  v_mul_f32 v19, v19, v29
  v_mul_f32 v20, v20, v29
  v_mul_f32 v21, v21, v29
  v_mul_f32 v22, v22, v29
  v_mul_f32 v23, v23, v29
  v_mul_f32 v25, v25, v29
L_keep_60:
  v_sub_f32 v26, v26, v24
  v_sub_f32 v27, v27, v24
  v_mul_f32 v26, s70, v26
  v_mul_f32 v27, s70, v27
  v_exp_f32 v26, v26
  v_exp_f32 v27, v27
  s_nop 0
  v_cvt_pk_bf16_f32 v28, v26, v26
  v_cvt_pk_bf16_f32 v29, v27, v27
  v_add_f32 v25, v25, v26
  v_and_b32 v40, v28, v12
  v_and_b32 v41, v28, v13
  v_and_b32 v42, v28, v14
  v_and_b32 v43, v28, v15
  v_and_b32 v44, v29, v12
  v_and_b32 v45, v29, v13
  v_and_b32 v46, v29, v14
  v_and_b32 v47, v29, v15
  v_add_f32 v25, v25, v27
  v_mfma_f32_16x16x32_bf16 v[16:19], v[80:83], v[40:43], v[16:19]
  v_mfma_f32_16x16x32_bf16 v[20:23], v[84:87], v[40:43], v[20:23]
  v_mfma_f32_16x16x32_bf16 v[16:19], v[88:91], v[44:47], v[16:19]
  v_mfma_f32_16x16x32_bf16 v[20:23], v[92:95], v[44:47], v[20:23]
  s_branch L_merge
L_drain1:
  s_waitcnt vmcnt(16)
  v_mfma_f32_16x16x32_bf16 v[32:35], v[128:131], v[4:7], 0
  v_mfma_f32_16x16x32_bf16 v[36:39], v[136:139], v[4:7], 0
  v_mfma_f32_16x16x32_bf16 v[32:35], v[132:135], v[8:11], v[32:35]
  v_mfma_f32_16x16x32_bf16 v[36:39], v[140:143], v[8:11], v[36:39]
  s_nop 7
  v_mov_b32_dpp v26, v32 quad_perm:[0,0,0,0] row_mask:0xf bank_mask:0xf
  v_mov_b32_dpp v27, v36 quad_perm:[0,0,0,0] row_mask:0xf bank_mask:0xf
  v_mov_b32_dpp v28, v34 quad_perm:[2,2,2,2] row_mask:0xf bank_mask:0xf
  v_mov_b32_dpp v29, v38 quad_perm:[2,2,2,2] row_mask:0xf bank_mask:0xf
  v_add_f32_dpp v26, v33, v26 quad_perm:[1,1,1,1] row_mask:0xf bank_mask:0xf
  v_add_f32_dpp v27, v37, v27 quad_perm:[1,1,1,1] row_mask:0xf bank_mask:0xf
  v_add_f32_dpp v28, v35, v28 quad_perm:[3,3,3,3] row_mask:0xf bank_mask:0xf
  v_add_f32_dpp v29, v39, v29 quad_perm:[3,3,3,3] row_mask:0xf bank_mask:0xf
  v_add_f32 v26, v26, v28
  v_add_f32 v27, v27, v29
  v_cvt_pk_bf16_f32 v28, v26, v27
  v_lshlrev_b32 v26, 16, v28
  v_and_b32 v27, 0xffff0000, v28
  v_add_f32 v27, s11, v27
  v_max_f32 v28, v26, v27
  v_cmp_gt_f32 vcc, v28, v24
  s_cbranch_vccz L_keep_61
  v_mov_b32 v29, v28
  s_nop 1
  v_permlane16_swap_b32 v28, v29
  v_max_f32 v28, v28, v29
  v_mov_b32 v29, v28
  s_nop 1
  v_permlane32_swap_b32 v28, v29
  v_max_f32 v28, v28, v29
  v_max_f32 v28, v28, v24
  v_sub_f32 v29, v24, v28
  v_mul_f32 v29, s70, v29
  v_exp_f32 v29, v29
  v_mov_b32 v24, v28
  v_mul_f32 v16, v16, v29
  v_mul_f32 v17, v17, v29
  v_mul_f32 v18, v18, v29
  v_mul_f32 v19, v19, v29
  v_mul_f32 v20, v20, v29
  v_mul_f32 v21, v21, v29
  v_mul_f32 v22, v22, v29
  v_mul_f32 v23, v23, v29
  v_mul_f32 v25, v25, v29
L_keep_61:
  v_sub_f32 v26, v26, v24
  v_sub_f32 v27, v27, v24
  v_mul_f32 v26, s70, v26
  v_mul_f32 v27, s70, v27
  v_exp_f32 v26, v26
  v_exp_f32 v27, v27
  s_nop 0
  v_cvt_pk_bf16_f32 v28, v26, v26
  v_cvt_pk_bf16_f32 v29, v27, v27
  v_add_f32 v25, v25, v26
  v_and_b32 v40, v28, v12
  v_and_b32 v41, v28, v13
  v_and_b32 v42, v28, v14
  v_and_b32 v43, v28, v15
  v_and_b32 v44, v29, v12
  v_and_b32 v45, v29, v13
  v_and_b32 v46, v29, v14
  v_and_b32 v47, v29, v15
  v_add_f32 v25, v25, v27
  v_mfma_f32_16x16x32_bf16 v[16:19], v[144:147], v[40:43], v[16:19]
  v_mfma_f32_16x16x32_bf16 v[20:23], v[148:151], v[40:43], v[20:23]
  v_mfma_f32_16x16x32_bf16 v[16:19], v[152:155], v[44:47], v[16:19]
  v_mfma_f32_16x16x32_bf16 v[20:23], v[156:159], v[44:47], v[20:23]
  s_waitcnt vmcnt(8)
  v_mfma_f32_16x16x32_bf16 v[32:35], v[64:67], v[4:7], 0
  v_mfma_f32_16x16x32_bf16 v[36:39], v[72:75], v[4:7], 0
  v_mfma_f32_16x16x32_bf16 v[32:35], v[68:71], v[8:11], v[32:35]
  v_mfma_f32_16x16x32_bf16 v[36:39], v[76:79], v[8:11], v[36:39]
  s_nop 7
  v_mov_b32_dpp v26, v32 quad_perm:[0,0,0,0] row_mask:0xf bank_mask:0xf
  v_mov_b32_dpp v27, v36 quad_perm:[0,0,0,0] row_mask:0xf bank_mask:0xf
  v_mov_b32_dpp v28, v34 quad_perm:[2,2,2,2] row_mask:0xf bank_mask:0xf
  v_mov_b32_dpp v29, v38 quad_perm:[2,2,2,2] row_mask:0xf bank_mask:0xf
  v_add_f32_dpp v26, v33, v26 quad_perm:[1,1,1,1] row_mask:0xf bank_mask:0xf
  v_add_f32_dpp v27, v37, v27 quad_perm:[1,1,1,1] row_mask:0xf bank_mask:0xf
  v_add_f32_dpp v28, v35, v28 quad_perm:[3,3,3,3] row_mask:0xf bank_mask:0xf
  v_add_f32_dpp v29, v39, v29 quad_perm:[3,3,3,3] row_mask:0xf bank_mask:0xf
  v_add_f32 v26, v26, v28
  v_add_f32 v27, v27, v29
  v_cvt_pk_bf16_f32 v28, v26, v27
  v_lshlrev_b32 v26, 16, v28
  v_and_b32 v27, 0xffff0000, v28
  v_add_f32 v27, s9, v27
  v_max_f32 v28, v26, v27
  v_cmp_gt_f32 vcc, v28, v24
  s_cbranch_vccz L_keep_62
  v_mov_b32 v29, v28
  s_nop 1
  v_permlane16_swap_b32 v28, v29
  v_max_f32 v28, v28, v29
  v_mov_b32 v29, v28
  s_nop 1
  v_permlane32_swap_b32 v28, v29
  v_max_f32 v28, v28, v29
  v_max_f32 v28, v28, v24
  v_sub_f32 v29, v24, v28
  v_mul_f32 v29, s70, v29
  v_exp_f32 v29, v29
  v_mov_b32 v24, v28
  v_mul_f32 v16, v16, v29
  v_mul_f32 v17, v17, v29
  v_mul_f32 v18, v18, v29
  v_mul_f32 v19, v19, v29
  v_mul_f32 v20, v20, v29
  v_mul_f32 v21, v21, v29
  v_mul_f32 v22, v22, v29
  v_mul_f32 v23, v23, v29
  v_mul_f32 v25, v25, v29
L_keep_62:
  v_sub_f32 v26, v26, v24
  v_sub_f32 v27, v27, v24
  v_mul_f32 v26, s70, v26
  v_mul_f32 v27, s70, v27
  v_exp_f32 v26, v26
  v_exp_f32 v27, v27
  s_nop 0
  v_cvt_pk_bf16_f32 v28, v26, v26
  v_cvt_pk_bf16_f32 v29, v27, v27
  v_add_f32 v25, v25, v26
  v_and_b32 v40, v28, v12
  v_and_b32 v41, v28, v13
  v_and_b32 v42, v28, v14
  v_and_b32 v43, v28, v15
  v_and_b32 v44, v29, v12
  v_and_b32 v45, v29, v13
  v_and_b32 v46, v29, v14
  v_and_b32 v47, v29, v15
  v_add_f32 v25, v25, v27
  v_mfma_f32_16x16x32_bf16 v[16:19], v[80:83], v[40:43], v[16:19]
  v_mfma_f32_16x16x32_bf16 v[20:23], v[84:87], v[40:43], v[20:23]
  v_mfma_f32_16x16x32_bf16 v[16:19], v[88:91], v[44:47], v[16:19]
  v_mfma_f32_16x16x32_bf16 v[20:23], v[92:95], v[44:47], v[20:23]
  s_waitcnt vmcnt(0)
  v_mfma_f32_16x16x32_bf16 v[32:35], v[96:99], v[4:7], 0
  v_mfma_f32_16x16x32_bf16 v[36:39], v[104:107], v[4:7], 0
  v_mfma_f32_16x16x32_bf16 v[32:35], v[100:103], v[8:11], v[32:35]
  v_mfma_f32_16x16x32_bf16 v[36:39], v[108:111], v[8:11], v[36:39]
  s_nop 7
  v_mov_b32_dpp v26, v32 quad_perm:[0,0,0,0] row_mask:0xf bank_mask:0xf
  v_mov_b32_dpp v27, v36 quad_perm:[0,0,0,0] row_mask:0xf bank_mask:0xf
  v_mov_b32_dpp v28, v34 quad_perm:[2,2,2,2] row_mask:0xf bank_mask:0xf
  v_mov_b32_dpp v29, v38 quad_perm:[2,2,2,2] row_mask:0xf bank_mask:0xf
  v_add_f32_dpp v26, v33, v26 quad_perm:[1,1,1,1] row_mask:0xf bank_mask:0xf
  v_add_f32_dpp v27, v37, v27 quad_perm:[1,1,1,1] row_mask:0xf bank_mask:0xf
  v_add_f32_dpp v28, v35, v28 quad_perm:[3,3,3,3] row_mask:0xf bank_mask:0xf
  v_add_f32_dpp v29, v39, v29 quad_perm:[3,3,3,3] row_mask:0xf bank_mask:0xf
  v_add_f32 v26, v26, v28
  v_add_f32 v27, v27, v29
  v_cvt_pk_bf16_f32 v28, v26, v27
  v_lshlrev_b32 v26, 16, v28
  v_and_b32 v27, 0xffff0000, v28
  v_add_f32 v27, s10, v27
  v_max_f32 v28, v26, v27
  v_cmp_gt_f32 vcc, v28, v24
  s_cbranch_vccz L_keep_63
  v_mov_b32 v29, v28
  s_nop 1
  v_permlane16_swap_b32 v28, v29
  v_max_f32 v28, v28, v29
  v_mov_b32 v29, v28
  s_nop 1
  v_permlane32_swap_b32 v28, v29
  v_max_f32 v28, v28, v29
  v_max_f32 v28, v28, v24
  v_sub_f32 v29, v24, v28
  v_mul_f32 v29, s70, v29
  v_exp_f32 v29, v29
  v_mov_b32 v24, v28
  v_mul_f32 v16, v16, v29
  v_mul_f32 v17, v17, v29
  v_mul_f32 v18, v18, v29
  v_mul_f32 v19, v19, v29
  v_mul_f32 v20, v20, v29
  v_mul_f32 v21, v21, v29
  v_mul_f32 v22, v22, v29
  v_mul_f32 v23, v23, v29
  v_mul_f32 v25, v25, v29
L_keep_63:
  v_sub_f32 v26, v26, v24
  v_sub_f32 v27, v27, v24
  v_mul_f32 v26, s70, v26
  v_mul_f32 v27, s70, v27
  v_exp_f32 v26, v26
  v_exp_f32 v27, v27
  s_nop 0
  v_cvt_pk_bf16_f32 v28, v26, v26
  v_cvt_pk_bf16_f32 v29, v27, v27
  v_add_f32 v25, v25, v26
  v_and_b32 v40, v28, v12
  v_and_b32 v41, v28, v13
  v_and_b32 v42, v28, v14
  v_and_b32 v43, v28, v15
  v_and_b32 v44, v29, v12
  v_and_b32 v45, v29, v13
  v_and_b32 v46, v29, v14
  v_and_b32 v47, v29, v15
  v_add_f32 v25, v25, v27
  v_mfma_f32_16x16x32_bf16 v[16:19], v[112:115], v[40:43], v[16:19]
  v_mfma_f32_16x16x32_bf16 v[20:23], v[116:119], v[40:43], v[20:23]
  v_mfma_f32_16x16x32_bf16 v[16:19], v[120:123], v[44:47], v[16:19]
  v_mfma_f32_16x16x32_bf16 v[20:23], v[124:127], v[44:47], v[20:23]
  s_branch L_merge
L_drain2:
  s_waitcnt vmcnt(16)
  v_mfma_f32_16x16x32_bf16 v[32:35], v[64:67], v[4:7], 0
  v_mfma_f32_16x16x32_bf16 v[36:39], v[72:75], v[4:7], 0
  v_mfma_f32_16x16x32_bf16 v[32:35], v[68:71], v[8:11], v[32:35]
  v_mfma_f32_16x16x32_bf16 v[36:39], v[76:79], v[8:11], v[36:39]
  s_nop 7
  v_mov_b32_dpp v26, v32 quad_perm:[0,0,0,0] row_mask:0xf bank_mask:0xf
  v_mov_b32_dpp v27, v36 quad_perm:[0,0,0,0] row_mask:0xf bank_mask:0xf
  v_mov_b32_dpp v28, v34 quad_perm:[2,2,2,2] row_mask:0xf bank_mask:0xf
  v_mov_b32_dpp v29, v38 quad_perm:[2,2,2,2] row_mask:0xf bank_mask:0xf
  v_add_f32_dpp v26, v33, v26 quad_perm:[1,1,1,1] row_mask:0xf bank_mask:0xf
  v_add_f32_dpp v27, v37, v27 quad_perm:[1,1,1,1] row_mask:0xf bank_mask:0xf
  v_add_f32_dpp v28, v35, v28 quad_perm:[3,3,3,3] row_mask:0xf bank_mask:0xf
  v_add_f32_dpp v29, v39, v29 quad_perm:[3,3,3,3] row_mask:0xf bank_mask:0xf
  v_add_f32 v26, v26, v28
  v_add_f32 v27, v27, v29
  v_cvt_pk_bf16_f32 v28, v26, v27
  v_lshlrev_b32 v26, 16, v28
  v_and_b32 v27, 0xffff0000, v28
  v_add_f32 v27, s9, v27
  v_max_f32 v28, v26, v27
  v_cmp_gt_f32 vcc, v28, v24
  s_cbranch_vccz L_keep_64
  v_mov_b32 v29, v28
  s_nop 1
  v_permlane16_swap_b32 v28, v29
  v_max_f32 v28, v28, v29
  v_mov_b32 v29, v28
  s_nop 1
  v_permlane32_swap_b32 v28, v29
  v_max_f32 v28, v28, v29
  v_max_f32 v28, v28, v24
  v_sub_f32 v29, v24, v28
  v_mul_f32 v29, s70, v29
  v_exp_f32 v29, v29
  v_mov_b32 v24, v28
  v_mul_f32 v16, v16, v29
  v_mul_f32 v17, v17, v29
  v_mul_f32 v18, v18, v29
  v_mul_f32 v19, v19, v29
  v_mul_f32 v20, v20, v29
  v_mul_f32 v21, v21, v29
  v_mul_f32 v22, v22, v29
  v_mul_f32 v23, v23, v29
  v_mul_f32 v25, v25, v29
L_keep_64:
  v_sub_f32 v26, v26, v24
  v_sub_f32 v27, v27, v24
  v_mul_f32 v26, s70, v26
  v_mul_f32 v27, s70, v27
  v_exp_f32 v26, v26
  v_exp_f32 v27, v27
  s_nop 0
  v_cvt_pk_bf16_f32 v28, v26, v26
  v_cvt_pk_bf16_f32 v29, v27, v27
  v_add_f32 v25, v25, v26
  v_and_b32 v40, v28, v12
  v_and_b32 v41, v28, v13
  v_and_b32 v42, v28, v14
  v_and_b32 v43, v28, v15
  v_and_b32 v44, v29, v12
  v_and_b32 v45, v29, v13
  v_and_b32 v46, v29, v14
  v_and_b32 v47, v29, v15
  v_add_f32 v25, v25, v27
  v_mfma_f32_16x16x32_bf16 v[16:19], v[80:83], v[40:43], v[16:19]
  v_mfma_f32_16x16x32_bf16 v[20:23], v[84:87], v[40:43], v[20:23]
  v_mfma_f32_16x16x32_bf16 v[16:19], v[88:91], v[44:47], v[16:19]
  v_mfma_f32_16x16x32_bf16 v[20:23], v[92:95], v[44:47], v[20:23]
  s_waitcnt vmcnt(8)
  v_mfma_f32_16x16x32_bf16 v[32:35], v[96:99], v[4:7], 0
  v_mfma_f32_16x16x32_bf16 v[36:39], v[104:107], v[4:7], 0
  v_mfma_f32_16x16x32_bf16 v[32:35], v[100:103], v[8:11], v[32:35]
  v_mfma_f32_16x16x32_bf16 v[36:39], v[108:111], v[8:11], v[36:39]
  s_nop 7
  v_mov_b32_dpp v26, v32 quad_perm:[0,0,0,0] row_mask:0xf bank_mask:0xf
  v_mov_b32_dpp v27, v36 quad_perm:[0,0,0,0] row_mask:0xf bank_mask:0xf
  v_mov_b32_dpp v28, v34 quad_perm:[2,2,2,2] row_mask:0xf bank_mask:0xf
  v_mov_b32_dpp v29, v38 quad_perm:[2,2,2,2] row_mask:0xf bank_mask:0xf
  v_add_f32_dpp v26, v33, v26 quad_perm:[1,1,1,1] row_mask:0xf bank_mask:0xf
  v_add_f32_dpp v27, v37, v27 quad_perm:[1,1,1,1] row_mask:0xf bank_mask:0xf
  v_add_f32_dpp v28, v35, v28 quad_perm:[3,3,3,3] row_mask:0xf bank_mask:0xf
  v_add_f32_dpp v29, v39, v29 quad_perm:[3,3,3,3] row_mask:0xf bank_mask:0xf
  v_add_f32 v26, v26, v28
  v_add_f32 v27, v27, v29
  v_cvt_pk_bf16_f32 v28, v26, v27
  v_lshlrev_b32 v26, 16, v28
  v_and_b32 v27, 0xffff0000, v28
  v_add_f32 v27, s10, v27
  v_max_f32 v28, v26, v27
  v_cmp_gt_f32 vcc, v28, v24
  s_cbranch_vccz L_keep_65
  v_mov_b32 v29, v28
  s_nop 1
  v_permlane16_swap_b32 v28, v29
  v_max_f32 v28, v28, v29
  v_mov_b32 v29, v28
  s_nop 1
  v_permlane32_swap_b32 v28, v29
  v_max_f32 v28, v28, v29
  v_max_f32 v28, v28, v24
  v_sub_f32 v29, v24, v28
  v_mul_f32 v29, s70, v29
  v_exp_f32 v29, v29
  v_mov_b32 v24, v28
  v_mul_f32 v16, v16, v29
  v_mul_f32 v17, v17, v29
  v_mul_f32 v18, v18, v29
  v_mul_f32 v19, v19, v29
  v_mul_f32 v20, v20, v29
  v_mul_f32 v21, v21, v29
  v_mul_f32 v22, v22, v29
  v_mul_f32 v23, v23, v29
  v_mul_f32 v25, v25, v29
L_keep_65:
  v_sub_f32 v26, v26, v24
  v_sub_f32 v27, v27, v24
  v_mul_f32 v26, s70, v26
  v_mul_f32 v27, s70, v27
  v_exp_f32 v26, v26
  v_exp_f32 v27, v27
  s_nop 0
  v_cvt_pk_bf16_f32 v28, v26, v26
  v_cvt_pk_bf16_f32 v29, v27, v27
  v_add_f32 v25, v25, v26
  v_and_b32 v40, v28, v12
  v_and_b32 v41, v28, v13
  v_and_b32 v42, v28, v14
  v_and_b32 v43, v28, v15
  v_and_b32 v44, v29, v12
  v_and_b32 v45, v29, v13
  v_and_b32 v46, v29, v14
  v_and_b32 v47, v29, v15
  v_add_f32 v25, v25, v27
  v_mfma_f32_16x16x32_bf16 v[16:19], v[112:115], v[40:43], v[16:19]
  v_mfma_f32_16x16x32_bf16 v[20:23], v[116:119], v[40:43], v[20:23]
  v_mfma_f32_16x16x32_bf16 v[16:19], v[120:123], v[44:47], v[16:19]
  v_mfma_f32_16x16x32_bf16 v[20:23], v[124:127], v[44:47], v[20:23]
  s_waitcnt vmcnt(0)
  v_mfma_f32_16x16x32_bf16 v[32:35], v[128:131], v[4:7], 0
  v_mfma_f32_16x16x32_bf16 v[36:39], v[136:139], v[4:7], 0
  v_mfma_f32_16x16x32_bf16 v[32:35], v[132:135], v[8:11], v[32:35]
  v_mfma_f32_16x16x32_bf16 v[36:39], v[140:143], v[8:11], v[36:39]
  s_nop 7
  v_mov_b32_dpp v26, v32 quad_perm:[0,0,0,0] row_mask:0xf bank_mask:0xf
  v_mov_b32_dpp v27, v36 quad_perm:[0,0,0,0] row_mask:0xf bank_mask:0xf
  v_mov_b32_dpp v28, v34 quad_perm:[2,2,2,2] row_mask:0xf bank_mask:0xf
  v_mov_b32_dpp v29, v38 quad_perm:[2,2,2,2] row_mask:0xf bank_mask:0xf
  v_add_f32_dpp v26, v33, v26 quad_perm:[1,1,1,1] row_mask:0xf bank_mask:0xf
  v_add_f32_dpp v27, v37, v27 quad_perm:[1,1,1,1] row_mask:0xf bank_mask:0xf
  v_add_f32_dpp v28, v35, v28 quad_perm:[3,3,3,3] row_mask:0xf bank_mask:0xf
  v_add_f32_dpp v29, v39, v29 quad_perm:[3,3,3,3] row_mask:0xf bank_mask:0xf
  v_add_f32 v26, v26, v28
  v_add_f32 v27, v27, v29
  v_cvt_pk_bf16_f32 v28, v26, v27
  v_lshlrev_b32 v26, 16, v28
  v_and_b32 v27, 0xffff0000, v28
  v_add_f32 v27, s11, v27
  v_max_f32 v28, v26, v27
  v_cmp_gt_f32 vcc, v28, v24
  s_cbranch_vccz L_keep_66
  v_mov_b32 v29, v28
  s_nop 1
  v_permlane16_swap_b32 v28, v29
  v_max_f32 v28, v28, v29
  v_mov_b32 v29, v28
  s_nop 1
  v_permlane32_swap_b32 v28, v29
  v_max_f32 v28, v28, v29
  v_max_f32 v28, v28, v24
  v_sub_f32 v29, v24, v28
  v_mul_f32 v29, s70, v29
  v_exp_f32 v29, v29
  v_mov_b32 v24, v28
  v_mul_f32 v16, v16, v29
  v_mul_f32 v17, v17, v29
  v_mul_f32 v18, v18, v29
  v_mul_f32 v19, v19, v29
  v_mul_f32 v20, v20, v29
  v_mul_f32 v21, v21, v29
  v_mul_f32 v22, v22, v29
  v_mul_f32 v23, v23, v29
  v_mul_f32 v25, v25, v29
L_keep_66:
  v_sub_f32 v26, v26, v24
  v_sub_f32 v27, v27, v24
  v_mul_f32 v26, s70, v26
  v_mul_f32 v27, s70, v27
  v_exp_f32 v26, v26
  v_exp_f32 v27, v27
  s_nop 0
  v_cvt_pk_bf16_f32 v28, v26, v26
  v_cvt_pk_bf16_f32 v29, v27, v27
  v_add_f32 v25, v25, v26
  v_and_b32 v40, v28, v12
  v_and_b32 v41, v28, v13
  v_and_b32 v42, v28, v14
  v_and_b32 v43, v28, v15
  v_and_b32 v44, v29, v12
  v_and_b32 v45, v29, v13
  v_and_b32 v46, v29, v14
  v_and_b32 v47, v29, v15
  v_add_f32 v25, v25, v27
  v_mfma_f32_16x16x32_bf16 v[16:19], v[144:147], v[40:43], v[16:19]
  v_mfma_f32_16x16x32_bf16 v[20:23], v[148:151], v[40:43], v[20:23]
  v_mfma_f32_16x16x32_bf16 v[16:19], v[152:155], v[44:47], v[16:19]
  v_mfma_f32_16x16x32_bf16 v[20:23], v[156:159], v[44:47], v[20:23]
L_merge:
  s_add_u32 s78, s3, 8192
  v_mov_b32 v26, v25
  s_nop 1
  v_permlane16_swap_b32 v25, v26
  v_add_f32 v25, v25, v26
  v_mov_b32 v26, v25
  s_nop 1
  v_permlane32_swap_b32 v25, v26
  v_add_f32 v25, v25, v26
  ds_write_b64 v48, v[24:25] offset:2048
  ds_write_b128 v49, v[16:19] offset:4096
  ds_write_b128 v49, v[20:23] offset:4112
  s_waitcnt lgkmcnt(0)
  s_barrier
  s_cmp_ge_u32 s56, 2
  s_cbranch_scc1 L_pub
  ds_read_b64 v[96:97], v50 offset:2048
  ds_read_b64 v[98:99], v50 offset:2064
  ds_read_b64 v[100:101], v50 offset:2080
  ds_read_b64 v[102:103], v50 offset:2096
  ds_read_b64 v[104:105], v50 offset:2112
  ds_read_b64 v[106:107], v50 offset:2128
  ds_read_b64 v[108:109], v50 offset:2144
  ds_read_b64 v[110:111], v50 offset:2160
  ds_read_b128 v[64:67], v51 offset:4096
  ds_read_b128 v[68:71], v51 offset:6144
  ds_read_b128 v[72:75], v51 offset:8192
  ds_read_b128 v[76:79], v51 offset:10240
  ds_read_b128 v[80:83], v51 offset:12288
  ds_read_b128 v[84:87], v51 offset:14336
  ds_read_b128 v[88:91], v51 offset:16384
  ds_read_b128 v[92:95], v51 offset:18432
  s_mov_b32 s74, 0xf0f0f0f0
  s_mov_b32 s75, 0xf0f0f0f0
  s_mov_b32 s18, 0x7060500
  s_mov_b32 s19, 0x7060501
  s_mov_b32 s20, 0x7060502
  s_mov_b32 s21, 0x7060503
  s_waitcnt lgkmcnt(8)
  v_max3_f32 v32, v96, v98, v100
  v_max3_f32 v33, v102, v104, v106
  v_max3_f32 v32, v32, v108, v110
  v_max_f32 v32, v32, v33
  v_sub_f32 v112, v96, v32
  v_sub_f32 v113, v98, v32
  v_sub_f32 v114, v100, v32
  v_sub_f32 v115, v102, v32
  v_sub_f32 v116, v104, v32
  v_sub_f32 v117, v106, v32
  v_sub_f32 v118, v108, v32
  v_sub_f32 v119, v110, v32
  v_pk_mul_f32 v[112:113], s[70:71], v[112:113] op_sel_hi:[0,1]
  v_pk_mul_f32 v[114:115], s[70:71], v[114:115] op_sel_hi:[0,1]
  v_pk_mul_f32 v[116:117], s[70:71], v[116:117] op_sel_hi:[0,1]
  v_pk_mul_f32 v[118:119], s[70:71], v[118:119] op_sel_hi:[0,1]
  v_exp_f32 v112, v112
  v_exp_f32 v113, v113
  v_exp_f32 v114, v114
  v_exp_f32 v115, v115
  v_exp_f32 v116, v116
  v_exp_f32 v117, v117
  v_exp_f32 v118, v118
  v_exp_f32 v119, v119
  s_waitcnt lgkmcnt(0)
  v_pk_mul_f32 v[36:37], v[112:113], v[64:65] op_sel_hi:[0,1]
  v_pk_mul_f32 v[38:39], v[112:113], v[66:67] op_sel_hi:[0,1]
  v_mul_f32 v33, v112, v97
  v_pk_fma_f32 v[36:37], v[112:113], v[68:69], v[36:37] op_sel:[1,0,0] op_sel_hi:[1,1,1]
  v_pk_fma_f32 v[38:39], v[112:113], v[70:71], v[38:39] op_sel:[1,0,0] op_sel_hi:[1,1,1]
  v_fmac_f32 v33, v113, v99
  v_pk_fma_f32 v[36:37], v[114:115], v[72:73], v[36:37] op_sel_hi:[0,1,1]
  v_pk_fma_f32 v[38:39], v[114:115], v[74:75], v[38:39] op_sel_hi:[0,1,1]
  v_fmac_f32 v33, v114, v101
  v_pk_fma_f32 v[36:37], v[114:115], v[76:77], v[36:37] op_sel:[1,0,0] op_sel_hi:[1,1,1]
  v_pk_fma_f32 v[38:39], v[114:115], v[78:79], v[38:39] op_sel:[1,0,0] op_sel_hi:[1,1,1]
  v_fmac_f32 v33, v115, v103
  v_pk_fma_f32 v[36:37], v[116:117], v[80:81], v[36:37] op_sel_hi:[0,1,1]
  v_pk_fma_f32 v[38:39], v[116:117], v[82:83], v[38:39] op_sel_hi:[0,1,1]
  v_fmac_f32 v33, v116, v105
  v_pk_fma_f32 v[36:37], v[116:117], v[84:85], v[36:37] op_sel:[1,0,0] op_sel_hi:[1,1,1]
  v_pk_fma_f32 v[38:39], v[116:117], v[86:87], v[38:39] op_sel:[1,0,0] op_sel_hi:[1,1,1]
  v_fmac_f32 v33, v117, v107
  v_pk_fma_f32 v[36:37], v[118:119], v[88:89], v[36:37] op_sel_hi:[0,1,1]
  v_pk_fma_f32 v[38:39], v[118:119], v[90:91], v[38:39] op_sel_hi:[0,1,1]
  v_fmac_f32 v33, v118, v109
  v_pk_fma_f32 v[36:37], v[118:119], v[92:93], v[36:37] op_sel:[1,0,0] op_sel_hi:[1,1,1]
  v_pk_fma_f32 v[38:39], v[118:119], v[94:95], v[38:39] op_sel:[1,0,0] op_sel_hi:[1,1,1]
  v_fmac_f32 v33, v119, v111
  v_cndmask_b32 v32, v32, v33, s[74:75]
  v_perm_b32 v36, v36, v32, s18
  v_perm_b32 v37, v37, v32, s19
  v_perm_b32 v38, v38, v32, s20
  v_perm_b32 v39, v39, v32, s21
  buffer_store_dwordx4 v[36:39], v52, s[52:55], s98 offen sc1
L_pub:
  s_cmp_eq_u32 s68, 0
  s_cbranch_scc1 L_fin
  s_mov_b32 s76, 0
  s_barrier
  s_cmp_eq_u32 s68, 2
  s_cbranch_scc1 L_ffn
  s_mov_b32 s18, 0x0c0c0400
  s_mov_b32 s19, 0x04000c0c
L_cpoll:
  buffer_load_dwordx4 v[192:195], v55, s[52:55], s3 offen offset:0 sc1
  buffer_load_dwordx4 v[196:199], v55, s[52:55], s3 offen offset:64 sc1
  buffer_load_dwordx4 v[200:203], v55, s[52:55], s78 offen offset:0 sc1
  buffer_load_dwordx4 v[204:207], v55, s[52:55], s78 offen offset:64 sc1
L_cpoll_w:
  s_waitcnt vmcnt(0)
L_cpoll_c:
  v_max_u32 v26, v192, v193
  v_max3_u32 v26, v26, v194, v195
  v_max3_u32 v26, v26, v196, v197
  v_max3_u32 v26, v26, v198, v199
  v_max3_u32 v26, v26, v200, v201
  v_max3_u32 v26, v26, v202, v203
  v_max3_u32 v26, v26, v204, v205
  v_max3_u32 v26, v26, v206, v207
  v_cmp_eq_u32 vcc, -1, v26
  s_and_b64 exec, exec, vcc
  s_cbranch_scc0 L_cpoll_ok
  s_add_u32 s76, s76, 1
  s_cmp_lt_u32 s76, 2097152
  s_cbranch_scc1 L_cpoll
  s_mov_b64 exec, -1
  v_mov_b32 v26, 44
  v_mov_b32 v27, 3735879683
  global_store_dword v26, v27, s[36:37]
  s_branch L_cpoll_ok
L_cpoll_ok:
  s_mov_b64 exec, -1
  v_perm_b32 v208, v193, v192, s18
  v_perm_b32 v96, v195, v194, s19
  v_perm_b32 v210, v201, v200, s18
  v_perm_b32 v98, v203, v202, s19
  v_perm_b32 v209, v197, v196, s18
  v_perm_b32 v97, v199, v198, s19
  v_perm_b32 v211, v205, v204, s18
  v_perm_b32 v99, v207, v206, s19
  v_or_b32 v208, v208, v96
  v_or_b32 v210, v210, v98
  v_or_b32 v209, v209, v97
  v_or_b32 v211, v211, v99
  v_max_f32 v26, v208, v210
  s_nop 1
  v_max_f32_dpp v26, v26, v26 quad_perm:[1,0,3,2] row_mask:0xf bank_mask:0xf
  s_nop 1
  v_max_f32_dpp v26, v26, v26 quad_perm:[2,3,0,1] row_mask:0xf bank_mask:0xf
  s_nop 1
  v_max_f32_dpp v26, v26, v26 row_half_mirror row_mask:0xf bank_mask:0xf
  v_sub_f32 v28, v208, v26
  v_sub_f32 v29, v210, v26
  v_pk_mul_f32 v[28:29], s[70:71], v[28:29] op_sel_hi:[0,1]
  v_exp_f32 v28, v28
  v_exp_f32 v29, v29
  s_nop 0
  v_mul_f32 v27, v28, v209
  v_pk_mul_f32 v[96:97], v[28:29], v[192:193] op_sel_hi:[0,1]
  v_pk_mul_f32 v[98:99], v[28:29], v[194:195] op_sel_hi:[0,1]
  v_pk_mul_f32 v[100:101], v[28:29], v[196:197] op_sel_hi:[0,1]
  v_pk_mul_f32 v[102:103], v[28:29], v[198:199] op_sel_hi:[0,1]
  v_fmac_f32 v27, v29, v211
  v_pk_fma_f32 v[96:97], v[28:29], v[200:201], v[96:97] op_sel:[1,0,0] op_sel_hi:[1,1,1]
  v_pk_fma_f32 v[98:99], v[28:29], v[202:203], v[98:99] op_sel:[1,0,0] op_sel_hi:[1,1,1]
  v_pk_fma_f32 v[100:101], v[28:29], v[204:205], v[100:101] op_sel:[1,0,0] op_sel_hi:[1,1,1]
  v_pk_fma_f32 v[102:103], v[28:29], v[206:207], v[102:103] op_sel:[1,0,0] op_sel_hi:[1,1,1]
  s_nop 1
  v_add_f32_dpp v27, v27, v27 quad_perm:[1,0,3,2] row_mask:0xf bank_mask:0xf
  v_add_f32_dpp v96, v96, v96 quad_perm:[1,0,3,2] row_mask:0xf bank_mask:0xf
  v_add_f32_dpp v97, v97, v97 quad_perm:[1,0,3,2] row_mask:0xf bank_mask:0xf
  v_add_f32_dpp v98, v98, v98 quad_perm:[1,0,3,2] row_mask:0xf bank_mask:0xf
  v_add_f32_dpp v99, v99, v99 quad_perm:[1,0,3,2] row_mask:0xf bank_mask:0xf
  v_add_f32_dpp v100, v100, v100 quad_perm:[1,0,3,2] row_mask:0xf bank_mask:0xf
  v_add_f32_dpp v101, v101, v101 quad_perm:[1,0,3,2] row_mask:0xf bank_mask:0xf
  v_add_f32_dpp v102, v102, v102 quad_perm:[1,0,3,2] row_mask:0xf bank_mask:0xf
  v_add_f32_dpp v103, v103, v103 quad_perm:[1,0,3,2] row_mask:0xf bank_mask:0xf
  v_add_f32_dpp v27, v27, v27 quad_perm:[2,3,0,1] row_mask:0xf bank_mask:0xf
  v_add_f32_dpp v96, v96, v96 quad_perm:[2,3,0,1] row_mask:0xf bank_mask:0xf
  v_add_f32_dpp v97, v97, v97 quad_perm:[2,3,0,1] row_mask:0xf bank_mask:0xf
  v_add_f32_dpp v98, v98, v98 quad_perm:[2,3,0,1] row_mask:0xf bank_mask:0xf
  v_add_f32_dpp v99, v99, v99 quad_perm:[2,3,0,1] row_mask:0xf bank_mask:0xf
  v_add_f32_dpp v100, v100, v100 quad_perm:[2,3,0,1] row_mask:0xf bank_mask:0xf
  v_add_f32_dpp v101, v101, v101 quad_perm:[2,3,0,1] row_mask:0xf bank_mask:0xf
  v_add_f32_dpp v102, v102, v102 quad_perm:[2,3,0,1] row_mask:0xf bank_mask:0xf
  v_add_f32_dpp v103, v103, v103 quad_perm:[2,3,0,1] row_mask:0xf bank_mask:0xf
  v_add_f32_dpp v27, v27, v27 row_half_mirror row_mask:0xf bank_mask:0xf
  v_add_f32_dpp v96, v96, v96 row_half_mirror row_mask:0xf bank_mask:0xf
  v_add_f32_dpp v97, v97, v97 row_half_mirror row_mask:0xf bank_mask:0xf
  v_add_f32_dpp v98, v98, v98 row_half_mirror row_mask:0xf bank_mask:0xf
  v_add_f32_dpp v99, v99, v99 row_half_mirror row_mask:0xf bank_mask:0xf
  v_add_f32_dpp v100, v100, v100 row_half_mirror row_mask:0xf bank_mask:0xf
  v_add_f32_dpp v101, v101, v101 row_half_mirror row_mask:0xf bank_mask:0xf
  v_add_f32_dpp v102, v102, v102 row_half_mirror row_mask:0xf bank_mask:0xf
  v_add_f32_dpp v103, v103, v103 row_half_mirror row_mask:0xf bank_mask:0xf
  v_rcp_f32 v26, v27
  s_nop 0
  v_pk_mul_f32 v[96:97], v[26:27], v[96:97] op_sel_hi:[0,1]
  v_pk_mul_f32 v[98:99], v[26:27], v[98:99] op_sel_hi:[0,1]
  v_pk_mul_f32 v[100:101], v[26:27], v[100:101] op_sel_hi:[0,1]
  v_pk_mul_f32 v[102:103], v[26:27], v[102:103] op_sel_hi:[0,1]
  v_cvt_pk_bf16_f32 v40, v96, v97
  v_cvt_pk_bf16_f32 v41, v98, v99
  v_cvt_pk_bf16_f32 v42, v100, v101
  v_cvt_pk_bf16_f32 v43, v102, v103
  s_mov_b32 exec_lo, 0x1010101
  s_mov_b32 exec_hi, 0x1010101
  ds_write_b128 v56, v[40:43] offset:20480
  s_mov_b64 exec, -1
  s_waitcnt lgkmcnt(0)
  s_barrier
  s_cmp_ge_u32 s4, 28
  s_cbranch_scc1 L_fin
  ds_read_b128 v[64:67], v57 offset:20480
  ds_read_b128 v[68:71], v57 offset:20544
  ds_read_b128 v[72:75], v57 offset:20608
  ds_read_b128 v[76:79], v57 offset:20672
  ds_read_b128 v[80:83], v57 offset:20736
  ds_read_b128 v[84:87], v57 offset:20800
  ds_read_b128 v[88:91], v57 offset:20864
  ds_read_b128 v[92:95], v57 offset:20928
  s_waitcnt lgkmcnt(7)
  v_mfma_f32_16x16x32_bf16 v[32:35], v[160:163], v[64:67], 0
  s_waitcnt lgkmcnt(6)
  v_mfma_f32_16x16x32_bf16 v[36:39], v[164:167], v[68:71], 0
  s_waitcnt lgkmcnt(5)
  v_mfma_f32_16x16x32_bf16 v[32:35], v[168:171], v[72:75], v[32:35]
  s_waitcnt lgkmcnt(4)
  v_mfma_f32_16x16x32_bf16 v[36:39], v[172:175], v[76:79], v[36:39]
  s_waitcnt lgkmcnt(3)
  v_mfma_f32_16x16x32_bf16 v[32:35], v[176:179], v[80:83], v[32:35]
  s_waitcnt lgkmcnt(2)
  v_mfma_f32_16x16x32_bf16 v[36:39], v[180:183], v[84:87], v[36:39]
  s_waitcnt lgkmcnt(1)
  v_mfma_f32_16x16x32_bf16 v[32:35], v[184:187], v[88:91], v[32:35]
  s_waitcnt lgkmcnt(0)
  v_mfma_f32_16x16x32_bf16 v[36:39], v[188:191], v[92:95], v[36:39]
  s_mov_b32 exec_lo, 0x1010101
  s_mov_b32 exec_hi, 0x1010101
  s_nop 5
  v_pk_add_f32 v[32:33], v[32:33], v[36:37]
  v_pk_add_f32 v[34:35], v[34:35], v[38:39]
  buffer_store_dwordx4 v[32:35], v58, s[52:55], s5 offen sc1
  s_mov_b64 exec, -1
  s_branch L_fin
L_ffn:
  v_lshrrev_b32 v26, 4, v1
  v_and_b32 v27, 15, v1
  s_mov_b32 s48, s32
  s_mov_b32 s49, s33
  s_mov_b32 s50, 1605632
  s_mov_b32 s51, 0x20000
  v_mul_u32_u24 v28, 896, v26
  v_lshl_add_u32 v28, v27, 4, v28
  s_lshl_b32 s77, s69, 6
  s_lshl_b32 s78, s56, 3
  s_add_u32 s77, s77, s78
  s_mul_i32 s77, s77, 896
  buffer_load_dwordx4 v[216:219], v28, s[48:51], s77 offen offset:0 nt
  buffer_load_dwordx4 v[220:223], v28, s[48:51], s77 offen offset:256 nt
  buffer_load_dwordx4 v[224:227], v28, s[48:51], s77 offen offset:512 nt
  s_mov_b32 exec_lo, 0xff00ff
  s_mov_b32 exec_hi, 0xff00ff
  buffer_load_dwordx4 v[228:231], v28, s[48:51], s77 offen offset:768 nt
  s_mov_b64 exec, -1
  s_add_u32 s77, s77, 3584
  buffer_load_dwordx4 v[232:235], v28, s[48:51], s77 offen offset:0 nt
  buffer_load_dwordx4 v[236:239], v28, s[48:51], s77 offen offset:256 nt
  buffer_load_dwordx4 v[240:243], v28, s[48:51], s77 offen offset:512 nt
  s_mov_b32 exec_lo, 0xff00ff
  s_mov_b32 exec_hi, 0xff00ff
  buffer_load_dwordx4 v[244:247], v28, s[48:51], s77 offen offset:768 nt
  s_mov_b64 exec, -1
  v_mul_u32_u24 v28, 1040, v26
  v_lshl_add_u32 v28, v27, 4, v28
  s_mul_i32 s77, s56, 8320
  s_add_u32 s77, s77, 65536
  v_add_u32 v28, s77, v28
  v_lshlrev_b32 v29, 3, v26
  v_bfe_u32 v30, v1, 3, 1
  v_lshl_add_u32 v29, v30, 2, v29
  v_bfe_u32 v30, v1, 2, 1
  v_add_u32 v29, v29, v30
  v_mul_u32_u24 v29, 1040, v29
  v_and_b32 v30, 3, v1
  v_lshl_add_u32 v29, v30, 3, v29
  s_lshl_b32 s77, s56, 7
  s_add_u32 s77, s77, 65536
  v_add_u32 v29, s77, v29
  s_waitcnt vmcnt(0)
  ds_write_b128 v28, v[216:219] offset:0
  ds_write_b128 v28, v[220:223] offset:256
  ds_write_b128 v28, v[224:227] offset:512
  ds_write_b128 v28, v[228:231] offset:768
  ds_write_b128 v28, v[232:235] offset:4160
  ds_write_b128 v28, v[236:239] offset:4416
  ds_write_b128 v28, v[240:243] offset:4672
  ds_write_b128 v28, v[244:247] offset:4928
  s_waitcnt lgkmcnt(0)
  s_barrier
  ds_read_b64_tr_b16 v[216:217], v29 offset:0
  ds_read_b64_tr_b16 v[218:219], v29 offset:2080
  ds_read_b64_tr_b16 v[220:221], v29 offset:33280
  ds_read_b64_tr_b16 v[222:223], v29 offset:35360
  ds_read_b64_tr_b16 v[224:225], v29 offset:32
  ds_read_b64_tr_b16 v[226:227], v29 offset:2112
  ds_read_b64_tr_b16 v[228:229], v29 offset:33312
  ds_read_b64_tr_b16 v[230:231], v29 offset:35392
  ds_read_b64_tr_b16 v[232:233], v29 offset:64
  ds_read_b64_tr_b16 v[234:235], v29 offset:2144
  ds_read_b64_tr_b16 v[236:237], v29 offset:33344
  ds_read_b64_tr_b16 v[238:239], v29 offset:35424
  ds_read_b64_tr_b16 v[240:241], v29 offset:96
  ds_read_b64_tr_b16 v[242:243], v29 offset:2176
  ds_read_b64_tr_b16 v[244:245], v29 offset:33376
  ds_read_b64_tr_b16 v[246:247], v29 offset:35456
  v_lshlrev_b32 v28, 4, v1
  s_lshl_b32 s77, s56, 13
  s_add_u32 s77, s77, 2621440
  s_add_u32 s78, s77, 4096
  s_mul_i32 s79, s56, 3584
  v_add_u32 v29, s79, v28
  s_mov_b64 s[16:17], -1
  s_mov_b64 s[18:19], -1
  s_mov_b64 s[20:21], -1
  s_mov_b32 s22, -1
  s_mov_b32 s23, 0
  s_mov_b64 s[24:25], -1
  s_mov_b64 s[26:27], -1
  s_mov_b64 s[28:29], -1
  s_mov_b32 s30, -1
  s_mov_b32 s31, 0
  s_mov_b32 exec_lo, 0
  v_mov_b32 v76, 0
  v_mov_b32 v77, 0
  v_mov_b32 v78, 0
  v_mov_b32 v79, 0
  v_mov_b32 v92, 0
  v_mov_b32 v93, 0
  v_mov_b32 v94, 0
  v_mov_b32 v95, 0
L_fpoll:
  s_mov_b64 exec, s[16:17]
  s_cbranch_execz L_fs_67
  buffer_load_dwordx4 v[64:67], v28, s[52:55], s77 offen offset:0 sc1
L_fs_67:
  s_mov_b64 exec, s[18:19]
  s_cbranch_execz L_fs_68
  buffer_load_dwordx4 v[68:71], v28, s[52:55], s77 offen offset:1024 sc1
L_fs_68:
  s_mov_b64 exec, s[20:21]
  s_cbranch_execz L_fs_69
  buffer_load_dwordx4 v[72:75], v28, s[52:55], s77 offen offset:2048 sc1
L_fs_69:
  s_mov_b64 exec, s[22:23]
  s_cbranch_execz L_fs_70
  buffer_load_dwordx4 v[76:79], v28, s[52:55], s77 offen offset:3072 sc1
L_fs_70:
  s_mov_b64 exec, s[24:25]
  s_cbranch_execz L_fs_71
  buffer_load_dwordx4 v[80:83], v28, s[52:55], s78 offen offset:0 sc1
L_fs_71:
  s_mov_b64 exec, s[26:27]
  s_cbranch_execz L_fs_72
  buffer_load_dwordx4 v[84:87], v28, s[52:55], s78 offen offset:1024 sc1
L_fs_72:
  s_mov_b64 exec, s[28:29]
  s_cbranch_execz L_fs_73
  buffer_load_dwordx4 v[88:91], v28, s[52:55], s78 offen offset:2048 sc1
L_fs_73:
  s_mov_b64 exec, s[30:31]
  s_cbranch_execz L_fs_74
  buffer_load_dwordx4 v[92:95], v28, s[52:55], s78 offen offset:3072 sc1
L_fs_74:
  s_mov_b64 exec, -1
  s_waitcnt vmcnt(0)
  v_max3_u32 v32, v64, v65, v66
  v_max3_u32 v33, v68, v69, v70
  v_max3_u32 v34, v72, v73, v74
  v_max3_u32 v35, v76, v77, v78
  v_max3_u32 v36, v80, v81, v82
  v_max3_u32 v37, v84, v85, v86
  v_max3_u32 v38, v88, v89, v90
  v_max3_u32 v39, v92, v93, v94
  v_max_u32 v32, v32, v67
  v_max_u32 v33, v33, v71
  v_max_u32 v34, v34, v75
  v_max_u32 v35, v35, v79
  v_max_u32 v36, v36, v83
  v_max_u32 v37, v37, v87
  v_max_u32 v38, v38, v91
  v_max_u32 v39, v39, v95
  v_cmp_eq_u32 s[16:17], -1, v32
  v_cmp_eq_u32 s[18:19], -1, v33
  v_cmp_eq_u32 s[20:21], -1, v34
  v_cmp_eq_u32 s[22:23], -1, v35
  v_cmp_eq_u32 s[24:25], -1, v36
  v_cmp_eq_u32 s[26:27], -1, v37
  v_cmp_eq_u32 s[28:29], -1, v38
  v_cmp_eq_u32 s[30:31], -1, v39
  v_max3_u32 v26, v32, v33, v34
  v_max3_u32 v27, v35, v36, v37
  v_max3_u32 v26, v26, v38, v39
  v_max_u32 v26, v26, v27
  v_cmp_eq_u32 vcc, -1, v26
  s_cbranch_vccz L_fpoll_ok
  s_add_u32 s76, s76, 1
  s_cmp_lt_u32 s76, 2097152
  s_cbranch_scc1 L_fpoll
  s_mov_b64 exec, -1
  v_mov_b32 v26, 52
  v_mov_b32 v27, 3735879685
  global_store_dword v26, v27, s[36:37]
  s_branch L_fpoll_ok
L_fpoll_ok:
  v_pk_add_f32 v[64:65], v[64:65], v[80:81]
  v_pk_add_f32 v[66:67], v[66:67], v[82:83]
  v_pk_add_f32 v[68:69], v[68:69], v[84:85]
  v_pk_add_f32 v[70:71], v[70:71], v[86:87]
  v_pk_add_f32 v[72:73], v[72:73], v[88:89]
  v_pk_add_f32 v[74:75], v[74:75], v[90:91]
  v_pk_add_f32 v[76:77], v[76:77], v[92:93]
  v_pk_add_f32 v[78:79], v[78:79], v[94:95]
  ds_write_b128 v29, v[64:67] offset:32768
  ds_write_b128 v29, v[68:71] offset:33792
  ds_write_b128 v29, v[72:75] offset:34816
  s_mov_b32 exec_hi, 0
  ds_write_b128 v29, v[76:79] offset:35840
  s_mov_b32 exec_hi, -1
  s_waitcnt lgkmcnt(0)
  s_barrier
  s_cmp_ge_u32 s56, 4
  s_cbranch_scc1 L_hbar
  v_mov_b32 v64, 0
  v_mov_b32 v65, 0
  v_mov_b32 v66, 0
  v_mov_b32 v67, 0
  s_mov_b64 exec, s[6:7]
  ds_read_b128 v[64:67], v54 offset:32768
  ds_read_b128 v[68:71], v54 offset:36352
  ds_read_b128 v[72:75], v54 offset:39936
  ds_read_b128 v[76:79], v54 offset:43520
  ds_read_b128 v[80:83], v54 offset:47104
  ds_read_b128 v[84:87], v54 offset:50688
  ds_read_b128 v[88:91], v54 offset:54272
  ds_read_b128 v[92:95], v54 offset:57856
  s_waitcnt lgkmcnt(6)
  v_pk_add_f32 v[64:65], v[64:65], v[68:69]
  v_pk_add_f32 v[66:67], v[66:67], v[70:71]
  s_waitcnt lgkmcnt(4)
  v_pk_add_f32 v[72:73], v[72:73], v[76:77]
  v_pk_add_f32 v[74:75], v[74:75], v[78:79]
  s_waitcnt lgkmcnt(2)
  v_pk_add_f32 v[80:81], v[80:81], v[84:85]
  v_pk_add_f32 v[82:83], v[82:83], v[86:87]
  s_waitcnt lgkmcnt(0)
  v_pk_add_f32 v[88:89], v[88:89], v[92:93]
  v_pk_add_f32 v[90:91], v[90:91], v[94:95]
  v_pk_add_f32 v[64:65], v[64:65], v[72:73]
  v_pk_add_f32 v[66:67], v[66:67], v[74:75]
  v_pk_add_f32 v[80:81], v[80:81], v[88:89]
  v_pk_add_f32 v[82:83], v[82:83], v[90:91]
  v_pk_add_f32 v[64:65], v[64:65], v[80:81]
  v_pk_add_f32 v[66:67], v[66:67], v[82:83]
  s_mov_b64 exec, -1
  v_cvt_pk_bf16_f32 v26, v64, v65
  v_cvt_pk_bf16_f32 v27, v66, v67
  v_lshlrev_b32 v64, 16, v26
  v_and_b32 v65, 0xffff0000, v26
  v_lshlrev_b32 v66, 16, v27
  v_and_b32 v67, 0xffff0000, v27
  v_pk_add_f32 v[64:65], v[64:65], v[248:249]
  v_pk_add_f32 v[66:67], v[66:67], v[250:251]
  v_cvt_pk_bf16_f32 v26, v64, v65
  v_cvt_pk_bf16_f32 v27, v66, v67
  s_mov_b64 exec, s[6:7]
  ds_write_b64 v55, v[26:27] offset:22528
  s_mov_b64 exec, -1
  v_lshlrev_b32 v64, 16, v26
  v_and_b32 v65, 0xffff0000, v26
  v_lshlrev_b32 v66, 16, v27
  v_and_b32 v67, 0xffff0000, v27
  v_pk_add_f32 v[68:69], v[64:65], v[66:67]
  v_pk_mul_f32 v[70:71], v[64:65], v[64:65]
  v_pk_fma_f32 v[70:71], v[66:67], v[66:67], v[70:71]
  v_add_f32 v68, v68, v69
  v_add_f32 v69, v70, v71
  ds_write_b64 v56, v[68:69] offset:24576
  s_waitcnt lgkmcnt(0)
L_hbar:
  s_barrier
  ds_read_b128 v[40:43], v58 offset:24576
  ds_read_b128 v[44:47], v58 offset:24592
  ds_read_b128 v[64:67], v57 offset:22528
  ds_read_b128 v[68:71], v57 offset:22592
  ds_read_b128 v[72:75], v57 offset:22656
  ds_read_b128 v[76:79], v57 offset:22720
  ds_read_b128 v[80:83], v57 offset:22784
  ds_read_b128 v[84:87], v57 offset:22848
  ds_read_b128 v[88:91], v57 offset:22912
  ds_read_b128 v[92:95], v57 offset:22976
  ds_read_b128 v[96:99], v57 offset:23040
  ds_read_b128 v[100:103], v57 offset:23104
  ds_read_b128 v[104:107], v57 offset:23168
  ds_read_b128 v[108:111], v57 offset:23232
  ds_read_b128 v[112:115], v57 offset:23296
  s_waitcnt lgkmcnt(12)
  v_mfma_f32_16x16x32_bf16 v[32:35], v[160:163], v[64:67], 0
  ds_read_b128 v[116:119], v57 offset:23360
  v_pk_add_f32 v[40:41], v[40:41], v[42:43]
  v_pk_add_f32 v[44:45], v[44:45], v[46:47]
  v_pk_add_f32 v[40:41], v[40:41], v[44:45]
  s_nop 1
  s_waitcnt lgkmcnt(12)
  v_mfma_f32_16x16x32_bf16 v[36:39], v[164:167], v[68:71], 0
  v_add_f32_dpp v40, v40, v40 quad_perm:[1,0,3,2] row_mask:0xf bank_mask:0xf
  v_add_f32_dpp v41, v41, v41 quad_perm:[1,0,3,2] row_mask:0xf bank_mask:0xf
  s_nop 0
  v_add_f32_dpp v40, v40, v40 quad_perm:[2,3,0,1] row_mask:0xf bank_mask:0xf
  s_waitcnt lgkmcnt(11)
  v_mfma_f32_16x16x32_bf16 v[32:35], v[168:171], v[72:75], v[32:35]
  v_add_f32_dpp v41, v41, v41 quad_perm:[2,3,0,1] row_mask:0xf bank_mask:0xf
  s_nop 0
  v_add_f32_dpp v40, v40, v40 row_half_mirror row_mask:0xf bank_mask:0xf
  v_add_f32_dpp v41, v41, v41 row_half_mirror row_mask:0xf bank_mask:0xf
  s_waitcnt lgkmcnt(10)
  v_mfma_f32_16x16x32_bf16 v[36:39], v[172:175], v[76:79], v[36:39]
  v_mov_b32 v42, v40
  v_mov_b32 v43, v41
  s_nop 0
  v_permlane16_swap_b32 v40, v42
  s_waitcnt lgkmcnt(9)
  v_mfma_f32_16x16x32_bf16 v[32:35], v[176:179], v[80:83], v[32:35]
  v_permlane16_swap_b32 v41, v43
  v_add_f32 v40, v40, v42
  v_add_f32 v41, v41, v43
  v_mov_b32 v42, v40
  s_waitcnt lgkmcnt(8)
  v_mfma_f32_16x16x32_bf16 v[36:39], v[180:183], v[84:87], v[36:39]
  v_mov_b32 v43, v41
  s_nop 0
  v_permlane32_swap_b32 v40, v42
  v_permlane32_swap_b32 v41, v43
  s_waitcnt lgkmcnt(7)
  v_mfma_f32_16x16x32_bf16 v[32:35], v[184:187], v[88:91], v[32:35]
  v_add_f32 v40, v40, v42
  v_add_f32 v41, v41, v43
  s_mov_b32 s77, 0x3b124925
  v_pk_mul_f32 v[40:41], s[76:77], v[40:41] op_sel:[1,0] op_sel_hi:[1,1]
  s_waitcnt lgkmcnt(6)
  v_mfma_f32_16x16x32_bf16 v[36:39], v[188:191], v[92:95], v[36:39]
  v_fma_f32 v41, -v40, v40, v41
  v_max_f32 v41, 0, v41
  v_cvt_pk_bf16_f32 v26, v40, v41
  v_lshlrev_b32 v28, 16, v26
  s_waitcnt lgkmcnt(5)
  v_mfma_f32_16x16x32_bf16 v[32:35], v[192:195], v[96:99], v[32:35]
  v_and_b32 v26, 0xffff0000, v26
  v_add_f32 v26, 0x3727c5ac, v26
  v_cvt_pk_bf16_f32 v26, v26, v26
  v_lshlrev_b32 v26, 16, v26
  s_waitcnt lgkmcnt(4)
  v_mfma_f32_16x16x32_bf16 v[36:39], v[196:199], v[100:103], v[36:39]
  v_sqrt_f32 v26, v26
  s_nop 0
  v_cvt_pk_bf16_f32 v26, v26, v26
  v_lshlrev_b32 v26, 16, v26
  s_waitcnt lgkmcnt(3)
  v_mfma_f32_16x16x32_bf16 v[32:35], v[200:203], v[104:107], v[32:35]
  v_rcp_f32 v30, v26
  s_mov_b32 s77, 0xbdd2d3e8
  v_mov_b32 v46, 0xc0135761
  v_pk_mul_f32 v[40:41], v[28:29], v[252:253] op_sel_hi:[0,1]
  s_waitcnt lgkmcnt(2)
  v_mfma_f32_16x16x32_bf16 v[36:39], v[204:207], v[108:111], v[36:39]
  v_pk_mul_f32 v[42:43], v[28:29], v[254:255] op_sel_hi:[0,1]
  s_waitcnt lgkmcnt(1)
  v_mfma_f32_16x16x32_bf16 v[32:35], v[208:211], v[112:115], v[32:35]
  s_waitcnt lgkmcnt(0)
  v_mfma_f32_16x16x32_bf16 v[36:39], v[212:215], v[116:119], v[36:39]
  s_nop 7
  v_pk_add_f32 v[32:33], v[32:33], v[36:37]
  v_pk_add_f32 v[34:35], v[34:35], v[38:39]
  s_nop 1
  v_permlane32_swap_b32 v32, v34
  v_permlane32_swap_b32 v33, v35
  v_pk_add_f32 v[32:33], v[32:33], v[40:41] neg_lo:[0,1] neg_hi:[0,1]
  v_pk_add_f32 v[34:35], v[34:35], v[42:43] neg_lo:[0,1] neg_hi:[0,1]
  v_pk_mul_f32 v[32:33], v[30:31], v[32:33] op_sel_hi:[0,1]
  v_pk_mul_f32 v[34:35], v[30:31], v[34:35] op_sel_hi:[0,1]
  v_cvt_pk_bf16_f32 v26, v32, v33
  v_cvt_pk_bf16_f32 v27, v34, v35
  v_lshlrev_b32 v32, 16, v26
  v_and_b32 v33, 0xffff0000, v26
  v_lshlrev_b32 v34, 16, v27
  v_and_b32 v35, 0xffff0000, v27
  v_pk_mul_f32 v[26:27], v[32:33], v[32:33]
  v_fma_f32 v26, v26, s77, v46
  v_fma_f32 v27, v27, s77, v46
  v_pk_mul_f32 v[26:27], v[26:27], v[32:33]
  v_exp_f32 v26, v26
  v_exp_f32 v27, v27
  s_nop 0
  v_add_f32 v26, 1.0, v26
  v_add_f32 v27, 1.0, v27
  v_rcp_f32 v26, v26
  v_rcp_f32 v27, v27
  s_nop 0
  v_pk_mul_f32 v[26:27], v[26:27], v[32:33]
  v_cvt_pk_bf16_f32 v28, v26, v27
  v_lshlrev_b32 v26, 16, v28
  v_and_b32 v27, 0xffff0000, v28
  v_pk_mul_f32 v[26:27], v[26:27], v[34:35]
  v_cvt_pk_bf16_f32 v28, v26, v27
  s_mov_b32 exec_lo, 0x1010101
  s_mov_b32 exec_hi, 0x1010101
  ds_write_b32 v59, v28 offset:26624
  s_mov_b64 exec, -1
  s_waitcnt lgkmcnt(0)
  s_barrier
  s_cmp_eq_u32 s56, 7
  s_cbranch_scc1 L_final
  ds_read_b128 v[40:43], v60 offset:26624
  ds_read_b128 v[44:47], v60 offset:26688
  s_waitcnt lgkmcnt(1)
  v_mfma_f32_16x16x32_bf16 v[64:67], v[216:219], v[40:43], 0
  v_mfma_f32_16x16x32_bf16 v[68:71], v[224:227], v[40:43], 0
  v_mfma_f32_16x16x32_bf16 v[72:75], v[232:235], v[40:43], 0
  v_mfma_f32_16x16x32_bf16 v[76:79], v[240:243], v[40:43], 0
  s_waitcnt lgkmcnt(0)
  v_mfma_f32_16x16x32_bf16 v[64:67], v[220:223], v[44:47], v[64:67]
  v_mfma_f32_16x16x32_bf16 v[68:71], v[228:231], v[44:47], v[68:71]
  v_mfma_f32_16x16x32_bf16 v[72:75], v[236:239], v[44:47], v[72:75]
  v_mfma_f32_16x16x32_bf16 v[76:79], v[244:247], v[44:47], v[76:79]
  s_mov_b32 exec_lo, 0x1010101
  s_mov_b32 exec_hi, 0x1010101
  s_nop 2
  buffer_store_dwordx4 v[64:67], v61, s[52:55], s5 offen offset:0 sc1
  buffer_store_dwordx4 v[68:71], v61, s[52:55], s5 offen offset:128 sc1
  buffer_store_dwordx4 v[72:75], v61, s[52:55], s5 offen offset:256 sc1
  buffer_store_dwordx4 v[76:79], v61, s[52:55], s5 offen offset:384 sc1
  s_mov_b64 exec, -1
  s_waitcnt vmcnt(0)
  s_barrier
  s_branch L_fin
L_final:
  ds_read_b64 v[30:31], v63 offset:22528
  s_mov_b32 s48, s34
  s_mov_b32 s49, s35
  s_mov_b32 s50, 1792
  s_mov_b32 s51, 0x20000
  s_barrier
L_opoll:
  s_add_u32 s78, s4, 0
  buffer_load_dwordx4 v[64:67], v62, s[52:55], s78 offen sc1
  s_add_u32 s78, s4, 32768
  buffer_load_dwordx4 v[68:71], v62, s[52:55], s78 offen sc1
  s_add_u32 s78, s4, 65536
  buffer_load_dwordx4 v[72:75], v62, s[52:55], s78 offen sc1
  s_add_u32 s78, s4, 98304
  buffer_load_dwordx4 v[76:79], v62, s[52:55], s78 offen sc1
L_opoll_w:
  s_waitcnt vmcnt(0)
L_opoll_c:
  v_max_u32 v26, v64, v65
  v_max3_u32 v26, v26, v66, v67
  v_max3_u32 v26, v26, v68, v69
  v_max3_u32 v26, v26, v70, v71
  v_max3_u32 v26, v26, v72, v73
  v_max3_u32 v26, v26, v74, v75
  v_max3_u32 v26, v26, v76, v77
  v_max3_u32 v26, v26, v78, v79
  v_cmp_eq_u32 vcc, -1, v26
  s_and_b64 exec, exec, vcc
  s_cbranch_scc0 L_opoll_ok
  s_add_u32 s76, s76, 1
  s_cmp_lt_u32 s76, 2097152
  s_cbranch_scc1 L_opoll
  s_mov_b64 exec, -1
  v_mov_b32 v26, 56
  v_mov_b32 v27, 3735879686
  global_store_dword v26, v27, s[36:37]
  s_branch L_opoll_ok
L_opoll_ok:
  s_mov_b64 exec, -1
  v_pk_add_f32 v[64:65], v[64:65], v[68:69]
  v_pk_add_f32 v[66:67], v[66:67], v[70:71]
  v_pk_add_f32 v[72:73], v[72:73], v[76:77]
  v_pk_add_f32 v[74:75], v[74:75], v[78:79]
  v_pk_add_f32 v[32:33], v[64:65], v[72:73]
  v_pk_add_f32 v[34:35], v[66:67], v[74:75]
  s_nop 1
  v_add_f32_dpp v32, v32, v32 row_ror:8 row_mask:0xf bank_mask:0xf
  v_add_f32_dpp v33, v33, v33 row_ror:8 row_mask:0xf bank_mask:0xf
  v_add_f32_dpp v34, v34, v34 row_ror:8 row_mask:0xf bank_mask:0xf
  v_add_f32_dpp v35, v35, v35 row_ror:8 row_mask:0xf bank_mask:0xf
  v_mov_b32 v36, v32
  v_mov_b32 v37, v33
  v_mov_b32 v38, v34
  v_mov_b32 v39, v35
  v_permlane16_swap_b32 v32, v36
  v_permlane16_swap_b32 v33, v37
  v_permlane16_swap_b32 v34, v38
  v_permlane16_swap_b32 v35, v39
  v_add_f32 v32, v32, v36
  v_add_f32 v33, v33, v37
  v_add_f32 v34, v34, v38
  v_add_f32 v35, v35, v39
  v_mov_b32 v36, v32
  v_mov_b32 v37, v33
  v_mov_b32 v38, v34
  v_mov_b32 v39, v35
  v_permlane32_swap_b32 v32, v36
  v_permlane32_swap_b32 v33, v37
  v_permlane32_swap_b32 v34, v38
  v_permlane32_swap_b32 v35, v39
  v_add_f32 v32, v32, v36
  v_add_f32 v33, v33, v37
  v_add_f32 v34, v34, v38
  v_add_f32 v35, v35, v39
  v_cvt_pk_bf16_f32 v26, v32, v33
  v_cvt_pk_bf16_f32 v27, v34, v35
  v_lshlrev_b32 v32, 16, v26
  v_and_b32 v33, 0xffff0000, v26
  v_lshlrev_b32 v34, 16, v27
  v_and_b32 v35, 0xffff0000, v27
  s_waitcnt lgkmcnt(0)
  v_lshlrev_b32 v36, 16, v30
  v_and_b32 v37, 0xffff0000, v30
  v_lshlrev_b32 v38, 16, v31
  v_and_b32 v39, 0xffff0000, v31
  v_pk_add_f32 v[32:33], v[32:33], v[36:37]
  v_pk_add_f32 v[34:35], v[34:35], v[38:39]
  v_cvt_pk_bf16_f32 v26, v32, v33
  v_cvt_pk_bf16_f32 v27, v34, v35
  s_mov_b64 exec, 0xff
  buffer_store_dwordx2 v[26:27], v63, s[48:51], 0 offen
  s_cmp_lg_u32 s69, 0
  s_cbranch_scc1 L_noep
  v_mul_u32_u24 v29, 1572864, v1
  v_mov_b32 v30, s61
  s_mov_b64 exec, 3
  buffer_store_dword v30, v29, s[52:55], 0 offen
L_noep:
  s_mov_b64 exec, -1
L_fin:
L_end:
  s_endpgm
.section .rodata,"a"
.p2align 6
.amdhsa_kernel sequential_preLN__gqa_block_cached__geglu_ffn__decode_kernel
  .amdhsa_next_free_vgpr 256
  .amdhsa_next_free_sgpr 102
  .amdhsa_accum_offset 256
  .amdhsa_group_segment_fixed_size 0
  .amdhsa_kernarg_size 96
  .amdhsa_user_sgpr_count 2
  .amdhsa_user_sgpr_kernarg_segment_ptr 1
  .amdhsa_system_sgpr_workgroup_id_x 1
  .amdhsa_float_denorm_mode_32 3
.end_amdhsa_kernel
```
